```python
import torch

def _softmax(x, axis=-1):
    return torch.softmax(x, dim=axis)
def _gelu(x):
    return torch.nn.functional.gelu(x, approximate="tanh")
def _silu(x):
    return torch.nn.functional.silu(x)
def _sigmoid(x):
    return torch.sigmoid(x)
def _layernorm(x, axis=-1, eps=1e-5):
    m = x.mean(dim=axis, keepdim=True)
    v = x.var(dim=axis, keepdim=True, unbiased=False)
    return (x - m) / torch.sqrt(v + eps)
def _scatter_add(tgt, idx, src, axis=0):
    return tgt.clone().index_add_(axis, idx, src)
def _segment_sum(src, seg, n):
    out = torch.zeros((n,) + src.shape[1:], dtype=src.dtype)
    return out.index_add_(0, seg, src)
def _pad(x, pw):
    flat = tuple(v for pair in reversed(pw) for v in pair)
    return torch.nn.functional.pad(x, flat)

kernel_name = 'recurrent_scan__gqa_block_cached__glu_gated_reglu__decode'

def setup_inputs():

    _w = (lambda a: (lambda t: t.to(torch.bfloat16) if t.is_floating_point() else t)(torch.as_tensor(a)))
    def _A_setup():
        B, Sq, D = 4, 1, 640
        Hq, Hkv, Sk, Dh = 32, 32, 4096, 192
        assert Hq % Hkv == 0, (Hq, Hkv)
        return {
            "x": _w((lambda *s: torch.randn(*s, dtype=torch.bfloat16) * 0.05)(B, Sq, D)),
            "k_cache": _w((lambda *s: torch.randn(*s, dtype=torch.bfloat16) * 3.2)(B, Hkv, Sk, Dh)),
            "v_cache": _w((lambda *s: torch.randn(*s, dtype=torch.bfloat16) * 3.2)(B, Hkv, Sk, Dh)),
            "wq": _w((lambda *s: torch.randn(*s, dtype=torch.bfloat16) * 3.2)(D, Hq * Dh) * (D ** -0.5)),
            "wo": _w((lambda *s: torch.randn(*s, dtype=torch.bfloat16) * 3.2)(Hq * Dh, D) * ((Hq * Dh) ** -0.5)),
        }
    _A_in = _A_setup()

    def _B_setup():
        B, S, D, F = 4, 1, 640, 1536
        return {
            "x": _w((lambda *s: torch.randn(*s, dtype=torch.bfloat16) * 0.05)(B, S, D)),
            "W_gate": _w((lambda *s: torch.randn(*s, dtype=torch.bfloat16) * 0.4)(D, F) * (2.0 / D) ** 0.5),
            "W_up": _w((lambda *s: torch.randn(*s, dtype=torch.bfloat16) * 0.4)(D, F) * (2.0 / D) ** 0.5),
            "W_down": _w((lambda *s: torch.randn(*s, dtype=torch.bfloat16) * 0.4)(F, D) * (1.0 / F) ** 0.5),
        }
    _B_in = _B_setup()

    return {
        "A_x": _A_in["x"],
        "A_k_cache": _A_in["k_cache"],
        "A_v_cache": _A_in["v_cache"],
        "A_wq": _A_in["wq"],
        "A_wo": _A_in["wo"],
        "B_x": _B_in["x"],
        "B_W_gate": _B_in["W_gate"],
        "B_W_up": _B_in["W_up"],
        "B_W_down": _B_in["W_down"],
    }

def reference(A_x, A_k_cache, A_v_cache, A_wq, A_wo, B_x, B_W_gate, B_W_up, B_W_down):
    def _A_ref(x, k_cache, v_cache, wq, wo):
        B, Sq, D = x.shape
        Hq, Dh = 32, 192
        Hkv = k_cache.shape[1]
        rep = Hq // Hkv
        q = (lambda x, *d: x.permute(*d))((x @ wq).reshape(B, Sq, Hq, Dh), 0, 2, 1, 3)
        k = (lambda x, n, axis: torch.repeat_interleave(x, n, dim=axis))(k_cache, rep, axis=1)
        v = (lambda x, n, axis: torch.repeat_interleave(x, n, dim=axis))(v_cache, rep, axis=1)
        scores = torch.einsum("bhqd,bhkd->bhqk", q, k) * (Dh ** -0.5)
        p = _softmax(scores, axis=-1)
        o = torch.einsum("bhqk,bhkd->bhqd", p, v)
        return (lambda x, *d: x.permute(*d))(o, 0, 2, 1, 3).reshape(B, Sq, Hq * Dh) @ wo

    def _B_ref(x, W_gate, W_up, W_down):
        gate = torch.einsum("bsd,df->bsf", x, W_gate)
        up = torch.einsum("bsd,df->bsf", x, W_up)
        gate = gate * (lambda x, dt: x.to(dt))(gate > 0, gate.dtype)
        h = gate * up
        return torch.einsum("bsf,fd->bsd", h, W_down)

    x = A_x
    xn = _layernorm(x, axis=-1)
    s = _A_ref(xn, A_k_cache, A_v_cache, A_wq, A_wo)
    g = _silu(_B_ref(xn, B_W_gate, B_W_up, B_W_down))
    return x + s * g
```

```asm
; @launch grid=(256,1,1) block=(512,1,1) lds=133376
.amdgcn_target "amdgcn-amd-amdhsa--gfx950"
.text
.globl recurrent_scan__gqa_block_cached__glu_gated_reglu__decode_kernel
.p2align 8
.type recurrent_scan__gqa_block_cached__glu_gated_reglu__decode_kernel,@function
recurrent_scan__gqa_block_cached__glu_gated_reglu__decode_kernel:
  s_load_dwordx16 s[4:19], s[0:1], 0
  s_load_dwordx8 s[20:27], s[0:1], 64
  s_cmp_ge_u32 s2, 256
  s_cbranch_scc1 L_end
  v_lshrrev_b32 v2, 6, v0
  v_and_b32 v1, 63, v0
  s_and_b32 s28, s2, 7
  s_lshl_b32 s28, s28, 2
  s_lshr_b32 s29, s2, 6
  s_add_u32 s28, s28, s29
  v_readfirstlane_b32 s3, v2
  s_bfe_u32 s29, s2, 0x30003
  v_lshrrev_b32 v2, 3, v1
  v_and_b32 v3, 7, v1
  s_cmp_ge_u32 s3, 4
  s_cbranch_scc0 L_main
L_helper:
  s_sub_u32 s33, s3, 4
  s_mul_i32 s34, s33, 1280
  v_lshl_add_u32 v6, v1, 2, s34
  v_mov_b32 v7, 0
  v_mul_u32_u24 v8, 12288, v2
  v_lshl_add_u32 v8, v3, 4, v8
  s_and_b32 s52, s29, 1
  s_lshr_b32 s53, s29, 1
  s_mul_i32 s35, s52, 3932160
  s_mul_i32 s36, s28, 384
  s_add_u32 s35, s35, s36
  s_lshl_b32 s36, s53, 7
  s_add_u32 s35, s35, s36
  s_mul_i32 s36, s33, 983040
  s_add_u32 s35, s35, s36
  s_mul_i32 s36, s33, 10240
  s_mov_b32 s42, 7864320
  s_mov_b32 s43, 0x20000
  s_lshr_b32 s57, s2, 6
  s_lshl_b32 s57, s57, 4
  s_and_b32 s38, s2, 15
  s_add_u32 s57, s57, s38
  s_sub_u32 s57, s57, 16
  s_cmp_ge_u32 s29, 6
  s_cselect_b32 s57, s57, 48
  v_mov_b32 v9, 103488
  v_mov_b32 v10, 0
  v_mov_b32 v11, 0
  v_mov_b32 v12, 0
  v_mov_b32 v13, 0
  ds_write_b128 v9, v[10:13]
  ds_write_b128 v9, v[10:13] offset:16
  v_lshlrev_b32 v30, 4, v1
  v_add_u32 v30, 94720, v30
  ds_write_b128 v30, v[10:13]
  s_waitcnt lgkmcnt(0)
  s_mov_b32 s40, s10
  s_mov_b32 s41, s11
  global_load_dword v4, v7, s[26:27] sc1
  global_load_dword v10, v6, s[4:5] offset:0
  global_load_dword v11, v6, s[4:5] offset:256
  global_load_dword v12, v6, s[4:5] offset:512
  global_load_dword v13, v6, s[4:5] offset:768
  global_load_dword v14, v6, s[4:5] offset:1024
  s_cmp_ge_u32 s29, 6
  s_cbranch_scc1 L_nowq
  s_add_u32 m0, s36, 0
  s_nop 0
  buffer_load_dwordx4 v8, s[40:43], s35 offen nt lds
  s_add_u32 m0, s36, 1024
  s_add_u32 s35, s35, 98304
  buffer_load_dwordx4 v8, s[40:43], s35 offen nt lds
  s_add_u32 m0, s36, 2048
  s_add_u32 s35, s35, 98304
  buffer_load_dwordx4 v8, s[40:43], s35 offen nt lds
  s_add_u32 m0, s36, 3072
  s_add_u32 s35, s35, 98304
  buffer_load_dwordx4 v8, s[40:43], s35 offen nt lds
  s_add_u32 m0, s36, 4096
  s_add_u32 s35, s35, 98304
  buffer_load_dwordx4 v8, s[40:43], s35 offen nt lds
  s_add_u32 m0, s36, 5120
  s_add_u32 s35, s35, 98304
  buffer_load_dwordx4 v8, s[40:43], s35 offen nt lds
  s_add_u32 m0, s36, 6144
  s_add_u32 s35, s35, 98304
  buffer_load_dwordx4 v8, s[40:43], s35 offen nt lds
  s_add_u32 m0, s36, 7168
  s_add_u32 s35, s35, 98304
  buffer_load_dwordx4 v8, s[40:43], s35 offen nt lds
  s_add_u32 m0, s36, 8192
  s_add_u32 s35, s35, 98304
  buffer_load_dwordx4 v8, s[40:43], s35 offen nt lds
  s_add_u32 m0, s36, 9216
  s_add_u32 s35, s35, 98304
  buffer_load_dwordx4 v8, s[40:43], s35 offen nt lds
  s_branch L_wqdone
L_nowq:
  s_cmp_ge_u32 s57, 48
  s_cbranch_scc1 L_wqdone
  s_cmp_ge_u32 s57, 24
  s_cselect_b32 s50, 1, 0
  s_mul_i32 s51, s50, 24
  s_sub_u32 s51, s57, s51
  s_lshl_b32 s38, s33, 13
  s_lshr_b32 s49, s33, 1
  s_lshl1_add_u32 s49, s50, s49
  v_mul_u32_u24 v23, 3072, v2
  v_lshl_add_u32 v23, v3, 4, v23
  s_mul_i32 s39, s49, 491520
  s_lshl_b32 s35, s51, 7
  s_add_u32 s39, s39, s35
  s_bitcmp1_b32 s33, 0
  s_cselect_b32 s44, s18, s16
  s_cselect_b32 s45, s19, s17
  s_mov_b32 s46, 1966080
  s_mov_b32 s47, 0x20000
  s_add_u32 m0, s38, 0
  s_nop 0
  buffer_load_dwordx4 v23, s[44:47], s39 offen nt lds
  s_add_u32 m0, s38, 1024
  s_add_u32 s39, s39, 24576
  buffer_load_dwordx4 v23, s[44:47], s39 offen nt lds
  s_add_u32 m0, s38, 2048
  s_add_u32 s39, s39, 24576
  buffer_load_dwordx4 v23, s[44:47], s39 offen nt lds
  s_add_u32 m0, s38, 3072
  s_add_u32 s39, s39, 24576
  buffer_load_dwordx4 v23, s[44:47], s39 offen nt lds
  s_add_u32 m0, s38, 4096
  s_add_u32 s39, s39, 24576
  buffer_load_dwordx4 v23, s[44:47], s39 offen nt lds
  s_add_u32 m0, s38, 5120
  s_add_u32 s39, s39, 24576
  buffer_load_dwordx4 v23, s[44:47], s39 offen nt lds
  s_add_u32 m0, s38, 6144
  s_add_u32 s39, s39, 24576
  buffer_load_dwordx4 v23, s[44:47], s39 offen nt lds
  s_add_u32 m0, s38, 7168
  s_add_u32 s39, s39, 24576
  buffer_load_dwordx4 v23, s[44:47], s39 offen nt lds
L_wqdone:
  v_mov_b32 v30, 22
  s_cmp_lt_u32 s57, 48
  s_cselect_b32 s35, 8, 0
  v_add_u32 v30, s35, v30
  ds_write_b32 v9, v30 offset:16
  s_lshl_b32 s35, s33, 8
  s_add_u32 s35, s35, 132352
  v_lshl_add_u32 v30, v1, 2, s35
  ds_write_b32 v30, v7
  s_waitcnt lgkmcnt(0)
  s_barrier
  s_min_u32 s32, s2, 239
  s_mul_i32 s31, s32, 205
  s_lshr_b32 s31, s31, 11
  s_mul_i32 s36, s31, 10
  s_sub_u32 s32, s32, s36
  v_lshrrev_b32 v16, 4, v1
  v_and_b32 v17, 15, v1
  v_bfe_u32 v18, v1, 2, 2
  v_and_b32 v19, 3, v1
  v_lshl_add_u32 v20, v16, 3, v18
  v_lshlrev_b32 v21, 7, v20
  v_lshl_add_u32 v21, v19, 3, v21
  v_mul_u32_u24 v22, 160, v20
  v_lshl_add_u32 v22, v19, 3, v22
  v_add_u32 v22, 40960, v22
  v_mul_u32_u24 v24, 1280, v19
  v_lshl_add_u32 v24, v16, 4, v24
  v_add_u32 v24, 88064, v24
  s_mov_b32 s60, 0xffff0000
  s_mov_b32 s61, 0x3acccccd
  s_mov_b32 s62, 0x3727c5ac
  s_mov_b32 s63, 1069066811
  s_mov_b32 s59, 0xff
  s_mov_b32 s90, 0xffffff00
  s_mul_i32 s34, s52, 640
  v_add_u32 v26, s34, v24
  s_lshl_b32 s58, s33, 5
  v_add_u32 v54, s58, v21
  s_mul_i32 s34, s28, 12288
  s_add_u32 s34, s34, 4096
  s_lshl_b32 s35, s53, 2
  s_add_u32 s35, s35, s33
  s_lshl_b32 s35, s35, 1
  s_add_u32 s35, s35, s52
  s_lshl_b32 s35, s35, 9
  s_add_u32 s35, s35, s34
  v_lshl_add_u32 v28, v1, 4, s35
  s_mul_i32 s35, s33, 3072
  s_add_u32 s35, s35, s34
  v_lshl_add_u32 v29, v1, 4, s35
  s_mul_i32 s35, s33, 96
  s_add_u32 s35, s35, 93184
  v_lshl_add_u32 v27, v17, 1, s35
  v_cmp_eq_u32 s[88:89], 1, v16
  v_lshrrev_b32 v55, 1, v16
  v_mov_b32 v15, 1
  v_cndmask_b32 v56, v55, 3, s[88:89]
  v_mul_u32_u24 v56, 384, v56
  v_add_u32 v25, v27, v56
  v_lshl_add_u32 v27, v55, 5, v27
  v_add_u32 v27, 768, v27
  s_cmp_ge_u32 s29, 6
  s_cbranch_scc0 L_xw
  s_cmp_lt_u32 s57, 48
  s_cbranch_scc1 L_xw
  s_waitcnt vmcnt(0)
L_xw:
  s_waitcnt vmcnt(8)
  v_add_u32 v4, 1, v4
  v_lshlrev_b32 v30, 16, v10
  v_and_b32 v31, s60, v10
  v_lshlrev_b32 v32, 16, v11
  v_and_b32 v33, s60, v11
  v_lshlrev_b32 v34, 16, v12
  v_and_b32 v35, s60, v12
  v_lshlrev_b32 v36, 16, v13
  v_and_b32 v37, s60, v13
  v_lshlrev_b32 v38, 16, v14
  v_and_b32 v39, s60, v14
  v_mov_b32 v5, v4
  v_add_f32 v40, v30, v31
  v_add_f32 v41, v32, v33
  v_add_f32 v42, v34, v35
  v_add_f32 v43, v36, v37
  v_add_f32 v44, v38, v39
  v_add_f32 v40, v40, v41
  v_add_f32 v42, v42, v43
  v_add_f32 v40, v40, v44
  v_add_f32 v40, v40, v42
  s_nop 1
  v_add_f32_dpp v40, v40, v40 quad_perm:[1,0,3,2] row_mask:0xf bank_mask:0xf
  s_nop 1
  v_add_f32_dpp v40, v40, v40 quad_perm:[2,3,0,1] row_mask:0xf bank_mask:0xf
  s_nop 1
  v_add_f32_dpp v40, v40, v40 row_half_mirror row_mask:0xf bank_mask:0xf
  s_nop 1
  v_add_f32_dpp v40, v40, v40 row_mirror row_mask:0xf bank_mask:0xf
  v_mov_b32 v41, v40
  s_nop 1
  v_permlane16_swap_b32 v40, v41
  v_add_f32 v40, v40, v41
  v_mov_b32 v41, v40
  s_nop 1
  v_permlane32_swap_b32 v40, v41
  v_add_f32 v40, v40, v41
  v_mul_f32 v40, s61, v40
  v_sub_f32 v42, v30, v40
  v_sub_f32 v43, v31, v40
  v_sub_f32 v44, v32, v40
  v_sub_f32 v45, v33, v40
  v_sub_f32 v46, v34, v40
  v_sub_f32 v47, v35, v40
  v_sub_f32 v48, v36, v40
  v_sub_f32 v49, v37, v40
  v_sub_f32 v50, v38, v40
  v_sub_f32 v51, v39, v40
  v_mul_f32 v52, v42, v42
  v_mul_f32 v53, v43, v43
  v_fmac_f32 v52, v44, v44
  v_fmac_f32 v53, v45, v45
  v_fmac_f32 v52, v46, v46
  v_fmac_f32 v53, v47, v47
  v_fmac_f32 v52, v48, v48
  v_fmac_f32 v53, v49, v49
  v_fmac_f32 v52, v50, v50
  v_fmac_f32 v53, v51, v51
  v_add_f32 v52, v52, v53
  s_nop 1
  v_add_f32_dpp v52, v52, v52 quad_perm:[1,0,3,2] row_mask:0xf bank_mask:0xf
  s_nop 1
  v_add_f32_dpp v52, v52, v52 quad_perm:[2,3,0,1] row_mask:0xf bank_mask:0xf
  s_nop 1
  v_add_f32_dpp v52, v52, v52 row_half_mirror row_mask:0xf bank_mask:0xf
  s_nop 1
  v_add_f32_dpp v52, v52, v52 row_mirror row_mask:0xf bank_mask:0xf
  v_mov_b32 v53, v52
  s_nop 1
  v_permlane16_swap_b32 v52, v53
  v_add_f32 v52, v52, v53
  v_mov_b32 v53, v52
  s_nop 1
  v_permlane32_swap_b32 v52, v53
  v_add_f32 v52, v52, v53
  v_mul_f32 v52, s61, v52
  v_cvt_pk_bf16_f32 v40, v40, v52
  v_and_b32 v52, s60, v40
  v_lshlrev_b32 v40, 16, v40
  v_add_f32 v52, s62, v52
  v_cvt_pk_bf16_f32 v52, v52, v52
  v_and_b32 v52, s60, v52
  v_sqrt_f32 v52, v52
  v_sub_f32 v30, v30, v40
  v_sub_f32 v31, v31, v40
  v_sub_f32 v32, v32, v40
  v_sub_f32 v33, v33, v40
  v_sub_f32 v34, v34, v40
  v_sub_f32 v35, v35, v40
  v_sub_f32 v36, v36, v40
  v_sub_f32 v37, v37, v40
  v_sub_f32 v38, v38, v40
  v_sub_f32 v39, v39, v40
  v_cvt_pk_bf16_f32 v52, v52, v52
  v_and_b32 v52, s60, v52
  v_rcp_f32 v53, v52
  v_cvt_pk_bf16_f32 v42, v30, v31
  v_cvt_pk_bf16_f32 v43, v32, v33
  v_cvt_pk_bf16_f32 v44, v34, v35
  v_cvt_pk_bf16_f32 v45, v36, v37
  v_cvt_pk_bf16_f32 v46, v38, v39
  v_lshlrev_b32 v30, 16, v42
  v_and_b32 v31, s60, v42
  v_lshlrev_b32 v32, 16, v43
  v_and_b32 v33, s60, v43
  v_lshlrev_b32 v34, 16, v44
  v_and_b32 v35, s60, v44
  v_lshlrev_b32 v36, 16, v45
  v_and_b32 v37, s60, v45
  v_lshlrev_b32 v38, 16, v46
  v_and_b32 v39, s60, v46
  v_mul_f32 v42, v30, v53
  v_mul_f32 v43, v31, v53
  v_mul_f32 v44, v32, v53
  v_mul_f32 v45, v33, v53
  v_mul_f32 v46, v34, v53
  v_mul_f32 v47, v35, v53
  v_mul_f32 v48, v36, v53
  v_mul_f32 v49, v37, v53
  v_mul_f32 v50, v38, v53
  v_mul_f32 v51, v39, v53
  v_fma_f32 v30, -v42, v52, v30
  v_fma_f32 v31, -v43, v52, v31
  v_fma_f32 v32, -v44, v52, v32
  v_fma_f32 v33, -v45, v52, v33
  v_fma_f32 v34, -v46, v52, v34
  v_fma_f32 v35, -v47, v52, v35
  v_fma_f32 v36, -v48, v52, v36
  v_fma_f32 v37, -v49, v52, v37
  v_fma_f32 v38, -v50, v52, v38
  v_fma_f32 v39, -v51, v52, v39
  v_fmac_f32 v42, v30, v53
  v_fmac_f32 v43, v31, v53
  v_fmac_f32 v44, v32, v53
  v_fmac_f32 v45, v33, v53
  v_fmac_f32 v46, v34, v53
  v_fmac_f32 v47, v35, v53
  v_fmac_f32 v48, v36, v53
  v_fmac_f32 v49, v37, v53
  v_fmac_f32 v50, v38, v53
  v_fmac_f32 v51, v39, v53
  v_add_u32 v6, 88064, v6
  v_cvt_pk_bf16_f32 v30, v42, v43
  v_cvt_pk_bf16_f32 v31, v44, v45
  v_cvt_pk_bf16_f32 v32, v46, v47
  v_cvt_pk_bf16_f32 v33, v48, v49
  v_cvt_pk_bf16_f32 v34, v50, v51
  ds_write_b32 v6, v30 offset:0
  ds_write_b32 v6, v31 offset:256
  ds_write_b32 v6, v32 offset:512
  ds_write_b32 v6, v33 offset:768
  ds_write_b32 v6, v34 offset:1024
  s_cmp_ge_u32 s29, 6
  s_cbranch_scc1 L_noq
  s_waitcnt vmcnt(0)
  s_mov_b64 exec, 1
  ds_add_u32 v9, v15 offset:0
  s_mov_b64 exec, -1
  s_mov_b32 s95, 8000000
L_lw_1:
  ds_read_b32 v30, v9 offset:0
  s_sub_u32 s95, s95, 1
  s_cbranch_scc1 L_lwx_2
  s_waitcnt lgkmcnt(0)
  v_cmp_gt_u32 vcc, 4, v30
  s_cbranch_vccnz L_lw_1
L_lwx_2:
  ds_read_b128 v[60:63], v26 offset:0
  ds_read_b64_tr_b16 v[84:85], v54 offset:0
  ds_read_b64_tr_b16 v[86:87], v54 offset:512
  ds_read_b128 v[64:67], v26 offset:64
  ds_read_b64_tr_b16 v[88:89], v54 offset:4096
  ds_read_b64_tr_b16 v[90:91], v54 offset:4608
  ds_read_b128 v[68:71], v26 offset:128
  ds_read_b64_tr_b16 v[92:93], v54 offset:8192
  ds_read_b64_tr_b16 v[94:95], v54 offset:8704
  ds_read_b128 v[72:75], v26 offset:192
  ds_read_b64_tr_b16 v[96:97], v54 offset:12288
  ds_read_b64_tr_b16 v[98:99], v54 offset:12800
  ds_read_b128 v[76:79], v26 offset:256
  ds_read_b64_tr_b16 v[100:101], v54 offset:16384
  ds_read_b64_tr_b16 v[102:103], v54 offset:16896
  s_waitcnt lgkmcnt(12)
  v_mfma_f32_16x16x32_bf16 v[40:43], v[60:63], v[84:87], 0
  ds_read_b128 v[80:83], v26 offset:320
  ds_read_b64_tr_b16 v[104:105], v54 offset:20480
  ds_read_b64_tr_b16 v[106:107], v54 offset:20992
  s_waitcnt lgkmcnt(12)
  v_mfma_f32_16x16x32_bf16 v[40:43], v[64:67], v[88:91], v[40:43]
  ds_read_b128 v[60:63], v26 offset:384
  ds_read_b64_tr_b16 v[84:85], v54 offset:24576
  ds_read_b64_tr_b16 v[86:87], v54 offset:25088
  s_waitcnt lgkmcnt(12)
  v_mfma_f32_16x16x32_bf16 v[40:43], v[68:71], v[92:95], v[40:43]
  ds_read_b128 v[64:67], v26 offset:448
  ds_read_b64_tr_b16 v[88:89], v54 offset:28672
  ds_read_b64_tr_b16 v[90:91], v54 offset:29184
  s_waitcnt lgkmcnt(12)
  v_mfma_f32_16x16x32_bf16 v[40:43], v[72:75], v[96:99], v[40:43]
  ds_read_b128 v[68:71], v26 offset:512
  ds_read_b64_tr_b16 v[92:93], v54 offset:32768
  ds_read_b64_tr_b16 v[94:95], v54 offset:33280
  s_waitcnt lgkmcnt(12)
  v_mfma_f32_16x16x32_bf16 v[40:43], v[76:79], v[100:103], v[40:43]
  ds_read_b128 v[72:75], v26 offset:576
  ds_read_b64_tr_b16 v[96:97], v54 offset:36864
  ds_read_b64_tr_b16 v[98:99], v54 offset:37376
  s_waitcnt lgkmcnt(12)
  v_mfma_f32_16x16x32_bf16 v[40:43], v[80:83], v[104:107], v[40:43]
  s_waitcnt lgkmcnt(9)
  v_mfma_f32_16x16x32_bf16 v[40:43], v[60:63], v[84:87], v[40:43]
  s_waitcnt lgkmcnt(6)
  v_mfma_f32_16x16x32_bf16 v[40:43], v[64:67], v[88:91], v[40:43]
  s_waitcnt lgkmcnt(3)
  v_mfma_f32_16x16x32_bf16 v[40:43], v[68:71], v[92:95], v[40:43]
  s_waitcnt lgkmcnt(0)
  v_mfma_f32_16x16x32_bf16 v[40:43], v[72:75], v[96:99], v[40:43]
  v_mov_b32 v47, v4
  s_nop 6
  v_cndmask_b32 v44, v40, v43, s[88:89]
  v_mov_b32 v45, v41
  v_mov_b32 v46, v42
  s_mov_b32 exec_hi, 0
  global_store_dwordx4 v28, v[44:47], s[26:27] sc1
  s_mov_b32 exec_hi, -1
  s_waitcnt vmcnt(0)
  s_branch L_qg
L_noq:
  s_cmp_ge_u32 s57, 48
  s_cbranch_scc1 L_noq2
  s_mov_b64 exec, 1
  ds_add_u32 v9, v15 offset:0
  s_mov_b64 exec, -1
  s_mov_b32 s95, 8000000
L_lw_3:
  ds_read_b32 v30, v9 offset:0
  s_sub_u32 s95, s95, 1
  s_cbranch_scc1 L_lwx_4
  s_waitcnt lgkmcnt(0)
  v_cmp_gt_u32 vcc, 4, v30
  s_cbranch_vccnz L_lw_3
L_lwx_4:
  v_add_u32 v38, s38, v21
  s_mul_i32 s35, s49, 320
  v_add_u32 v39, s35, v24
  s_waitcnt vmcnt(4)
  ds_read_b128 v[48:51], v39 offset:0
  ds_read_b64_tr_b16 v[52:53], v38 offset:0
  ds_read_b64_tr_b16 v[54:55], v38 offset:512
  ds_read_b64_tr_b16 v[56:57], v38 offset:32
  ds_read_b64_tr_b16 v[58:59], v38 offset:544
  ds_read_b64_tr_b16 v[60:61], v38 offset:64
  ds_read_b64_tr_b16 v[62:63], v38 offset:576
  ds_read_b64_tr_b16 v[64:65], v38 offset:96
  ds_read_b64_tr_b16 v[66:67], v38 offset:608
  s_waitcnt lgkmcnt(0)
  s_add_u32 m0, s38, 0
  s_add_u32 s39, s39, 24576
  buffer_load_dwordx4 v23, s[44:47], s39 offen nt lds
  s_add_u32 m0, s38, 1024
  s_add_u32 s39, s39, 24576
  buffer_load_dwordx4 v23, s[44:47], s39 offen nt lds
  s_add_u32 m0, s38, 2048
  s_add_u32 s39, s39, 24576
  buffer_load_dwordx4 v23, s[44:47], s39 offen nt lds
  s_add_u32 m0, s38, 3072
  s_add_u32 s39, s39, 24576
  buffer_load_dwordx4 v23, s[44:47], s39 offen nt lds
  v_mfma_f32_16x16x32_bf16 v[112:115], v[48:51], v[52:55], 0
  v_mfma_f32_16x16x32_bf16 v[116:119], v[48:51], v[56:59], 0
  v_mfma_f32_16x16x32_bf16 v[120:123], v[48:51], v[60:63], 0
  v_mfma_f32_16x16x32_bf16 v[124:127], v[48:51], v[64:67], 0
  s_waitcnt vmcnt(4)
  ds_read_b128 v[48:51], v39 offset:64
  ds_read_b64_tr_b16 v[52:53], v38 offset:4096
  ds_read_b64_tr_b16 v[54:55], v38 offset:4608
  ds_read_b64_tr_b16 v[56:57], v38 offset:4128
  ds_read_b64_tr_b16 v[58:59], v38 offset:4640
  ds_read_b64_tr_b16 v[60:61], v38 offset:4160
  ds_read_b64_tr_b16 v[62:63], v38 offset:4672
  ds_read_b64_tr_b16 v[64:65], v38 offset:4192
  ds_read_b64_tr_b16 v[66:67], v38 offset:4704
  s_waitcnt lgkmcnt(0)
  s_add_u32 m0, s38, 4096
  s_add_u32 s39, s39, 24576
  buffer_load_dwordx4 v23, s[44:47], s39 offen nt lds
  s_add_u32 m0, s38, 5120
  s_add_u32 s39, s39, 24576
  buffer_load_dwordx4 v23, s[44:47], s39 offen nt lds
  s_add_u32 m0, s38, 6144
  s_add_u32 s39, s39, 24576
  buffer_load_dwordx4 v23, s[44:47], s39 offen nt lds
  s_add_u32 m0, s38, 7168
  s_add_u32 s39, s39, 24576
  buffer_load_dwordx4 v23, s[44:47], s39 offen nt lds
  v_mfma_f32_16x16x32_bf16 v[112:115], v[48:51], v[52:55], v[112:115]
  v_mfma_f32_16x16x32_bf16 v[116:119], v[48:51], v[56:59], v[116:119]
  v_mfma_f32_16x16x32_bf16 v[120:123], v[48:51], v[60:63], v[120:123]
  v_mfma_f32_16x16x32_bf16 v[124:127], v[48:51], v[64:67], v[124:127]
  s_waitcnt vmcnt(4)
  ds_read_b128 v[48:51], v39 offset:128
  ds_read_b64_tr_b16 v[52:53], v38 offset:0
  ds_read_b64_tr_b16 v[54:55], v38 offset:512
  ds_read_b64_tr_b16 v[56:57], v38 offset:32
  ds_read_b64_tr_b16 v[58:59], v38 offset:544
  ds_read_b64_tr_b16 v[60:61], v38 offset:64
  ds_read_b64_tr_b16 v[62:63], v38 offset:576
  ds_read_b64_tr_b16 v[64:65], v38 offset:96
  ds_read_b64_tr_b16 v[66:67], v38 offset:608
  s_waitcnt lgkmcnt(0)
  s_add_u32 m0, s38, 0
  s_add_u32 s39, s39, 24576
  buffer_load_dwordx4 v23, s[44:47], s39 offen nt lds
  s_add_u32 m0, s38, 1024
  s_add_u32 s39, s39, 24576
  buffer_load_dwordx4 v23, s[44:47], s39 offen nt lds
  s_add_u32 m0, s38, 2048
  s_add_u32 s39, s39, 24576
  buffer_load_dwordx4 v23, s[44:47], s39 offen nt lds
  s_add_u32 m0, s38, 3072
  s_add_u32 s39, s39, 24576
  buffer_load_dwordx4 v23, s[44:47], s39 offen nt lds
  v_mfma_f32_16x16x32_bf16 v[112:115], v[48:51], v[52:55], v[112:115]
  v_mfma_f32_16x16x32_bf16 v[116:119], v[48:51], v[56:59], v[116:119]
  v_mfma_f32_16x16x32_bf16 v[120:123], v[48:51], v[60:63], v[120:123]
  v_mfma_f32_16x16x32_bf16 v[124:127], v[48:51], v[64:67], v[124:127]
  s_waitcnt vmcnt(4)
  ds_read_b128 v[48:51], v39 offset:192
  ds_read_b64_tr_b16 v[52:53], v38 offset:4096
  ds_read_b64_tr_b16 v[54:55], v38 offset:4608
  ds_read_b64_tr_b16 v[56:57], v38 offset:4128
  ds_read_b64_tr_b16 v[58:59], v38 offset:4640
  ds_read_b64_tr_b16 v[60:61], v38 offset:4160
  ds_read_b64_tr_b16 v[62:63], v38 offset:4672
  ds_read_b64_tr_b16 v[64:65], v38 offset:4192
  ds_read_b64_tr_b16 v[66:67], v38 offset:4704
  s_waitcnt lgkmcnt(0)
  v_mfma_f32_16x16x32_bf16 v[112:115], v[48:51], v[52:55], v[112:115]
  v_mfma_f32_16x16x32_bf16 v[116:119], v[48:51], v[56:59], v[116:119]
  v_mfma_f32_16x16x32_bf16 v[120:123], v[48:51], v[60:63], v[120:123]
  v_mfma_f32_16x16x32_bf16 v[124:127], v[48:51], v[64:67], v[124:127]
  s_waitcnt vmcnt(0)
  ds_read_b128 v[48:51], v39 offset:256
  ds_read_b64_tr_b16 v[52:53], v38 offset:0
  ds_read_b64_tr_b16 v[54:55], v38 offset:512
  ds_read_b64_tr_b16 v[56:57], v38 offset:32
  ds_read_b64_tr_b16 v[58:59], v38 offset:544
  ds_read_b64_tr_b16 v[60:61], v38 offset:64
  ds_read_b64_tr_b16 v[62:63], v38 offset:576
  ds_read_b64_tr_b16 v[64:65], v38 offset:96
  ds_read_b64_tr_b16 v[66:67], v38 offset:608
  s_waitcnt lgkmcnt(0)
  v_mfma_f32_16x16x32_bf16 v[112:115], v[48:51], v[52:55], v[112:115]
  v_mfma_f32_16x16x32_bf16 v[116:119], v[48:51], v[56:59], v[116:119]
  v_mfma_f32_16x16x32_bf16 v[120:123], v[48:51], v[60:63], v[120:123]
  v_mfma_f32_16x16x32_bf16 v[124:127], v[48:51], v[64:67], v[124:127]
  s_lshl_b32 s35, s33, 10
  s_add_u32 s35, s35, 71680
  v_lshl_add_u32 v37, v17, 4, s35
  s_mov_b64 exec, 0xffff
  s_nop 3
  ds_write_b128 v37, v[112:115] offset:0
  ds_write_b128 v37, v[116:119] offset:256
  ds_write_b128 v37, v[120:123] offset:512
  ds_write_b128 v37, v[124:127] offset:768
  s_mov_b64 exec, -1
  s_branch L_qg
L_noq2:
  s_mov_b32 s95, 8000000
L_lw_5:
  s_sleep 2
  ds_read_b32 v30, v9 offset:24
  s_sub_u32 s95, s95, 1
  s_cbranch_scc1 L_lwx_6
  s_waitcnt lgkmcnt(0)
  v_cmp_gt_u32 vcc, 4, v30
  s_cbranch_vccnz L_lw_5
L_lwx_6:
  s_sleep 44
L_qg:
  global_load_dwordx4 v[60:63], v29, s[26:27] offset:0 sc1
  global_load_dwordx4 v[64:67], v29, s[26:27] offset:1024 sc1
  global_load_dwordx4 v[68:71], v29, s[26:27] offset:2048 sc1
  s_mov_b32 s72, 1000000
L_poll_7:
  s_waitcnt vmcnt(0)
  v_cmp_ne_u32 s[64:65], v63, v4
  v_cmp_ne_u32 s[66:67], v67, v4
  v_cmp_ne_u32 s[68:69], v71, v4
  s_or_b64 s[70:71], s[64:65], s[66:67]
  s_or_b64 s[70:71], s[70:71], s[68:69]
  s_cbranch_scc0 L_got_8
  s_sub_u32 s72, s72, 1
  s_cbranch_scc1 L_got_8
  s_sleep 8
  s_wqm_b64 exec, s[64:65]
  global_load_dwordx4 v[60:63], v29, s[26:27] offset:0 sc1
  s_wqm_b64 exec, s[66:67]
  global_load_dwordx4 v[64:67], v29, s[26:27] offset:1024 sc1
  s_wqm_b64 exec, s[68:69]
  global_load_dwordx4 v[68:71], v29, s[26:27] offset:2048 sc1
  s_mov_b64 exec, -1
  s_branch L_poll_7
L_got_8:
  v_mov_b32 v71, v70
  v_permlane32_swap_b32 v60, v61
  v_permlane32_swap_b32 v64, v65
  v_permlane32_swap_b32 v68, v69
  v_permlane32_swap_b32 v62, v66
  v_permlane32_swap_b32 v70, v71
  v_add_f32 v60, v60, v61
  v_add_f32 v64, v64, v65
  v_add_f32 v68, v68, v69
  v_add_f32 v62, v62, v66
  v_add_f32 v70, v70, v71
  v_cvt_pk_bf16_f32 v60, v60, v60
  v_cvt_pk_bf16_f32 v64, v64, v64
  v_cvt_pk_bf16_f32 v68, v68, v68
  v_cvt_pk_bf16_f32 v62, v62, v62
  v_cvt_pk_bf16_f32 v70, v70, v70
  s_mov_b32 exec_hi, 0xffff
  ds_write_b16 v25, v60
  ds_write_b16 v25, v64 offset:32
  ds_write_b16 v25, v68 offset:64
  s_mov_b32 exec_lo, 0xffff
  ds_write_b16 v27, v62
  s_mov_b32 exec_hi, 0
  ds_write_b16 v27, v70 offset:64
  s_mov_b64 exec, -1
  s_waitcnt lgkmcnt(0)
  s_barrier
  v_lshlrev_b32 v14, 3, v19
  v_lshrrev_b32 v14, v14, v4
  v_min_u32 v13, 1, v19
  v_mad_u32_u24 v14, v13, v4, v14
  s_mul_i32 s35, s29, 40960
  s_lshl_b32 s36, s28, 8
  s_add_u32 s35, s35, s36
  s_add_u32 s35, s35, 2883584
  v_lshl_add_u32 v31, v17, 4, s35
  v_add_u32 v32, 0x8000, v31
  s_lshl_b32 s36, s33, 13
  v_add_u32 v31, s36, v31
  s_mul_i32 s35, s28, 24576
  s_add_u32 s35, s35, 2097152
  s_mul_i32 s36, s29, 768
  s_add_u32 s36, s36, s35
  v_lshl_add_u32 v33, v1, 4, s36
  s_add_u32 s35, s35, 2688
  v_lshl_add_u32 v34, v1, 4, s35
  v_add_u32 v35, s58, v22
  s_cmp_ge_u32 s57, 48
  s_cbranch_scc1 L_nofat
  s_lshl_b32 s35, s33, 8
  s_add_u32 s35, s35, 71680
  v_lshlrev_b32 v37, 10, v16
  v_lshl_add_u32 v37, v17, 4, v37
  v_add_u32 v37, s35, v37
  ds_read_b128 v[48:51], v37
  s_lshl_b32 s51, s51, 2
  s_add_u32 s51, s51, s33
  s_lshl_b32 s35, s51, 8
  s_add_u32 s35, s35, 1703936
  v_lshl_add_u32 v42, v17, 4, s35
  s_lshl_b32 s35, s51, 9
  s_add_u32 s35, s35, 1638400
  v_lshl_add_u32 v38, v1, 4, s35
  s_waitcnt lgkmcnt(0)
  v_mov_b32 v52, v48
  v_mov_b32 v53, v49
  v_mov_b32 v54, v50
  v_mov_b32 v55, v51
  s_nop 0
  v_permlane32_swap_b32 v48, v52
  v_permlane32_swap_b32 v49, v53
  v_permlane32_swap_b32 v50, v54
  v_permlane32_swap_b32 v51, v55
  v_pk_add_f32 v[48:49], v[48:49], v[52:53]
  v_pk_add_f32 v[50:51], v[50:51], v[54:55]
  s_cmp_eq_u32 s50, 1
  s_cbranch_scc1 L_upper
  v_bfi_b32 v48, s59, v14, v48
  s_mov_b32 exec_hi, 0
  global_store_dwordx4 v38, v[48:51], s[26:27] sc1
  s_mov_b32 exec_hi, -1
  s_branch L_nofat
L_upper:
  v_mov_b32 v30, 132352
  s_mov_b32 s95, 8000000
L_lw_9:
  s_sleep 8
  ds_read_b32 v47, v30 offset:0
  s_sub_u32 s95, s95, 1
  s_cbranch_scc1 L_lwx_10
  s_waitcnt lgkmcnt(0)
  v_cmp_gt_u32 vcc, 6, v47
  s_cbranch_vccnz L_lw_9
L_lwx_10:
  s_mov_b32 s92, 0xffffffff
  s_mov_b32 s93, 0x0
  s_mov_b64 exec, s[92:93]
  global_load_dwordx4 v[52:55], v38, s[26:27] sc1
  s_mov_b32 s68, 1000000
L_poll_11:
  s_waitcnt vmcnt(0)
  v_cmp_ne_u32_sdwa s[64:65], v52, v14 src0_sel:BYTE_0 src1_sel:BYTE_0
  s_or_b64 s[66:67], s[64:65], s[64:65]
  s_cbranch_scc0 L_got_12
  s_sub_u32 s68, s68, 1
  s_cbranch_scc1 L_got_12
  s_sleep 16
  s_wqm_b64 exec, s[64:65]
  global_load_dwordx4 v[52:55], v38, s[26:27] sc1
  s_mov_b64 exec, s[92:93]
  s_branch L_poll_11
L_got_12:
  v_and_b32 v52, s90, v52
  s_mov_b64 exec, -1
  v_pk_add_f32 v[48:49], v[48:49], v[52:53]
  v_pk_add_f32 v[50:51], v[50:51], v[54:55]
  v_mov_b32 v52, v48
  v_mov_b32 v53, v49
  v_mov_b32 v54, v50
  v_mov_b32 v55, v51
  s_nop 0
  v_permlane16_swap_b32 v48, v52
  v_permlane16_swap_b32 v49, v53
  v_permlane16_swap_b32 v50, v54
  v_permlane16_swap_b32 v51, v55
  v_cvt_pk_bf16_f32 v48, v48, v52
  v_cvt_pk_bf16_f32 v49, v49, v53
  v_cvt_pk_bf16_f32 v50, v50, v54
  v_cvt_pk_bf16_f32 v51, v51, v55
  v_and_b32 v52, s60, v48
  v_lshlrev_b32 v48, 16, v48
  v_max_f32 v48, 0, v48
  v_mul_f32 v48, v48, v52
  v_and_b32 v53, s60, v49
  v_lshlrev_b32 v49, 16, v49
  v_max_f32 v49, 0, v49
  v_mul_f32 v49, v49, v53
  v_and_b32 v54, s60, v50
  v_lshlrev_b32 v50, 16, v50
  v_max_f32 v50, 0, v50
  v_mul_f32 v50, v50, v54
  v_and_b32 v55, s60, v51
  v_lshlrev_b32 v51, 16, v51
  v_max_f32 v51, 0, v51
  v_mul_f32 v51, v51, v55
  v_cvt_pk_bf16_f32 v48, v48, v49
  v_cvt_pk_bf16_f32 v49, v50, v51
  v_mov_b32 v50, v4
  v_mov_b32 v51, v4
  s_mov_b64 exec, 0xffff
  global_store_dwordx4 v42, v[48:51], s[26:27] sc1
  s_mov_b64 exec, -1
L_nofat:
  ds_read_b64_tr_b16 v[112:113], v35 offset:0
  ds_read_b64_tr_b16 v[114:115], v35 offset:640
  ds_read_b64_tr_b16 v[116:117], v35 offset:5120
  ds_read_b64_tr_b16 v[118:119], v35 offset:5760
  ds_read_b64_tr_b16 v[120:121], v35 offset:10240
  ds_read_b64_tr_b16 v[122:123], v35 offset:10880
  ds_read_b64_tr_b16 v[124:125], v35 offset:15360
  ds_read_b64_tr_b16 v[126:127], v35 offset:16000
  ds_read_b64_tr_b16 v[128:129], v35 offset:20480
  ds_read_b64_tr_b16 v[130:131], v35 offset:21120
  ds_read_b64_tr_b16 v[132:133], v35 offset:25600
  ds_read_b64_tr_b16 v[134:135], v35 offset:26240
  s_cmp_lg_u32 s33, 0
  s_cbranch_scc1 L_nofrag4
  s_waitcnt lgkmcnt(3)
  ds_read_b64_tr_b16 v[136:137], v22 offset:128
  ds_read_b64_tr_b16 v[138:139], v22 offset:768
  ds_read_b64_tr_b16 v[140:141], v22 offset:5248
  ds_read_b64_tr_b16 v[142:143], v22 offset:5888
  ds_read_b64_tr_b16 v[144:145], v22 offset:10368
  ds_read_b64_tr_b16 v[146:147], v22 offset:11008
  ds_read_b64_tr_b16 v[148:149], v22 offset:15488
  ds_read_b64_tr_b16 v[150:151], v22 offset:16128
  ds_read_b64_tr_b16 v[152:153], v22 offset:20608
  ds_read_b64_tr_b16 v[154:155], v22 offset:21248
  ds_read_b64_tr_b16 v[156:157], v22 offset:25728
  ds_read_b64_tr_b16 v[158:159], v22 offset:26368
L_nofrag4:
  s_waitcnt lgkmcnt(0)
  s_cmp_ge_u32 s2, 240
  s_cbranch_scc1 L_noffn
  v_add_u32 v36, s58, v21
  v_add_u32 v36, 79872, v36
  s_lshl_b32 s57, s31, 2
  s_add_u32 s57, s57, s33
  s_lshl_b32 s35, s57, 8
  s_add_u32 s35, s35, 1703936
  v_lshl_add_u32 v42, v17, 4, s35
  v_mov_b32 v30, 132352
  s_mov_b32 s95, 8000000
L_lw_13:
  s_sleep 8
  ds_read_b32 v47, v30 offset:0
  s_sub_u32 s95, s95, 1
  s_cbranch_scc1 L_lwx_14
  s_waitcnt lgkmcnt(0)
  v_cmp_gt_u32 vcc, 40, v47
  s_cbranch_vccnz L_lw_13
L_lwx_14:
  s_mov_b32 s92, 0xffff
  s_mov_b32 s93, 0x0
  s_mov_b64 exec, s[92:93]
  global_load_dwordx4 v[52:55], v42, s[26:27] sc1
  s_mov_b32 s68, 1000000
L_poll_15:
  s_waitcnt vmcnt(0)
  v_cmp_ne_u64 s[64:65], v[54:55], v[4:5]
  s_or_b64 s[66:67], s[64:65], s[64:65]
  s_cbranch_scc0 L_got_16
  s_sub_u32 s68, s68, 1
  s_cbranch_scc1 L_got_16
  s_sleep 16
  s_wqm_b64 exec, s[64:65]
  global_load_dwordx4 v[52:55], v42, s[26:27] sc1
  s_mov_b64 exec, s[92:93]
  s_branch L_poll_15
L_got_16:
  s_mov_b64 exec, -1
  s_add_u32 s35, s58, 103680
  v_lshl_add_u32 v48, v17, 1, s35
  s_mov_b64 exec, 0xffff
  ds_write_b16 v48, v52
  ds_write_b16_d16_hi v48, v52 offset:128
  ds_write_b16 v48, v53 offset:256
  ds_write_b16_d16_hi v48, v53 offset:384
  s_mov_b64 exec, 1
  ds_add_u32 v9, v15 offset:4
  s_mov_b64 exec, -1
  v_lshlrev_b32 v37, 7, v19
  v_lshl_add_u32 v37, v16, 4, v37
  v_add_u32 v37, 103680, v37
  s_lshl_b32 s57, s32, 2
  s_add_u32 s57, s57, s33
  s_mul_i32 s35, s57, 6144
  s_lshl_b32 s36, s31, 8
  s_add_u32 s35, s35, s36
  s_add_u32 s35, s35, 1769472
  v_lshl_add_u32 v23, v17, 4, s35
  s_mov_b32 s95, 8000000
L_lw_17:
  s_sleep 4
  ds_read_b32 v30, v9 offset:4
  s_sub_u32 s95, s95, 1
  s_cbranch_scc1 L_lwx_18
  s_waitcnt lgkmcnt(0)
  v_cmp_gt_u32 vcc, 4, v30
  s_cbranch_vccnz L_lw_17
L_lwx_18:
  ds_read_b128 v[48:51], v37
  ds_read_b128 v[52:55], v37 offset:64
  ds_read_b64_tr_b16 v[60:61], v36 offset:0
  ds_read_b64_tr_b16 v[62:63], v36 offset:512
  ds_read_b64_tr_b16 v[64:65], v36 offset:4096
  ds_read_b64_tr_b16 v[66:67], v36 offset:4608
  s_waitcnt lgkmcnt(0)
  v_mfma_f32_16x16x32_bf16 v[80:83], v[48:51], v[60:63], 0
  v_mfma_f32_16x16x32_bf16 v[80:83], v[52:55], v[64:67], v[80:83]
  s_nop 6
  s_mov_b64 exec, 0xffff
  v_bfi_b32 v80, s59, v14, v80
  global_store_dwordx4 v23, v[80:83], s[26:27] sc1
  s_mov_b64 exec, -1
L_noffn:
  v_mul_u32_u24 v39, 384, v19
  v_lshl_add_u32 v39, v16, 4, v39
  v_add_u32 v39, 128768, v39
  v_lshlrev_b32 v37, 3, v1
  v_add_u32 v37, 128768, v37
  s_mov_b32 s54, -1
  s_mov_b32 s55, 0xffff
  s_cmp_eq_u32 s33, 0
  s_cbranch_scc1 L_w0
  s_cmp_eq_u32 s33, 1
  s_cbranch_scc1 L_w1
  s_cmp_eq_u32 s33, 2
  s_cbranch_scc1 L_w2
  v_add_u32 v34, 18432, v34
  v_add_u32 v37, 1152, v37
  s_cmp_ge_u32 s2, 40
  s_cbranch_scc1 L_bc
  s_mul_i32 s35, s2, 6144
  s_add_u32 s35, s35, 1771520
  v_lshl_add_u32 v38, v1, 4, s35
  s_lshl_b32 s35, s2, 13
  s_add_u32 s35, s35, 2887680
  v_lshl_add_u32 v40, v1, 4, s35
  s_lshl_b32 s35, s2, 5
  v_mul_u32_u24 v41, 1280, v16
  v_lshl_add_u32 v41, v17, 1, v41
  v_add_u32 v41, s35, v41
  global_load_ushort v43, v41, s[4:5]
  v_mov_b32 v30, 132352
  s_mov_b32 s95, 8000000
L_lw_19:
  s_sleep 8
  ds_read_b32 v47, v30 offset:0
  s_sub_u32 s95, s95, 1
  s_cbranch_scc1 L_lwx_20
  s_waitcnt lgkmcnt(0)
  v_cmp_gt_u32 vcc, 70, v47
  s_cbranch_vccnz L_lw_19
L_lwx_20:
  global_load_dwordx4 v[48:51], v38, s[26:27] offset:-2048 sc1
  global_load_dwordx4 v[52:55], v38, s[26:27] offset:-1024 sc1
  global_load_dwordx4 v[56:59], v38, s[26:27] offset:0 sc1
  global_load_dwordx4 v[60:63], v38, s[26:27] offset:1024 sc1
  global_load_dwordx4 v[64:67], v38, s[26:27] offset:2048 sc1
  global_load_dwordx4 v[68:71], v38, s[26:27] offset:3072 sc1
  s_mov_b32 s78, 1000000
L_poll_21:
  s_waitcnt vmcnt(0)
  v_cmp_ne_u32_sdwa s[64:65], v48, v14 src0_sel:BYTE_0 src1_sel:BYTE_0
  v_cmp_ne_u32_sdwa s[66:67], v52, v14 src0_sel:BYTE_0 src1_sel:BYTE_0
  v_cmp_ne_u32_sdwa s[68:69], v56, v14 src0_sel:BYTE_0 src1_sel:BYTE_0
  v_cmp_ne_u32_sdwa s[70:71], v60, v14 src0_sel:BYTE_0 src1_sel:BYTE_0
  v_cmp_ne_u32_sdwa s[72:73], v64, v14 src0_sel:BYTE_0 src1_sel:BYTE_0
  v_cmp_ne_u32_sdwa s[74:75], v68, v14 src0_sel:BYTE_0 src1_sel:BYTE_0
  s_or_b64 s[76:77], s[64:65], s[66:67]
  s_or_b64 s[76:77], s[76:77], s[68:69]
  s_or_b64 s[76:77], s[76:77], s[70:71]
  s_or_b64 s[76:77], s[76:77], s[72:73]
  s_or_b64 s[76:77], s[76:77], s[74:75]
  s_cbranch_scc0 L_got_22
  s_sub_u32 s78, s78, 1
  s_cbranch_scc1 L_got_22
  s_sleep 16
  s_wqm_b64 exec, s[64:65]
  global_load_dwordx4 v[48:51], v38, s[26:27] offset:-2048 sc1
  s_wqm_b64 exec, s[66:67]
  global_load_dwordx4 v[52:55], v38, s[26:27] offset:-1024 sc1
  s_wqm_b64 exec, s[68:69]
  global_load_dwordx4 v[56:59], v38, s[26:27] offset:0 sc1
  s_wqm_b64 exec, s[70:71]
  global_load_dwordx4 v[60:63], v38, s[26:27] offset:1024 sc1
  s_wqm_b64 exec, s[72:73]
  global_load_dwordx4 v[64:67], v38, s[26:27] offset:2048 sc1
  s_wqm_b64 exec, s[74:75]
  global_load_dwordx4 v[68:71], v38, s[26:27] offset:3072 sc1
  s_mov_b64 exec, -1
  s_branch L_poll_21
L_got_22:
  v_and_b32 v48, s90, v48
  v_and_b32 v52, s90, v52
  v_and_b32 v56, s90, v56
  v_and_b32 v60, s90, v60
  v_and_b32 v64, s90, v64
  v_and_b32 v68, s90, v68
  v_pk_add_f32 v[48:49], v[48:49], v[52:53]
  v_pk_add_f32 v[50:51], v[50:51], v[54:55]
  v_pk_add_f32 v[56:57], v[56:57], v[60:61]
  v_pk_add_f32 v[58:59], v[58:59], v[62:63]
  v_pk_add_f32 v[64:65], v[64:65], v[68:69]
  v_pk_add_f32 v[66:67], v[66:67], v[70:71]
  v_pk_add_f32 v[48:49], v[48:49], v[56:57]
  v_pk_add_f32 v[50:51], v[50:51], v[58:59]
  v_pk_add_f32 v[48:49], v[48:49], v[64:65]
  v_pk_add_f32 v[50:51], v[50:51], v[66:67]
  s_nop 1
  v_permlane16_swap_b32 v48, v49
  v_permlane16_swap_b32 v50, v51
  v_add_f32 v48, v48, v49
  v_add_f32 v50, v50, v51
  s_nop 1
  v_permlane32_swap_b32 v48, v50
  v_add_f32 v48, v48, v50
  v_cvt_pk_bf16_f32 v48, v48, v48
  v_and_b32 v48, s60, v48
  v_mul_f32 v49, s63, v48
  v_exp_f32 v49, -v49
  v_lshlrev_b32 v43, 16, v43
  v_add_f32 v49, 1.0, v49
  v_rcp_f32 v50, v49
  s_nop 0
  v_mul_f32 v42, v48, v50
  v_cvt_pk_bf16_f32 v42, v42, v42
  v_and_b32 v42, s60, v42
  s_branch L_bc
L_w2:
  v_add_u32 v34, 12288, v34
  v_add_u32 v37, 768, v37
  s_branch L_bc
L_w1:
  v_add_u32 v34, 6144, v34
  v_add_u32 v37, 384, v37
  v_lshlrev_b32 v38, 8, v19
  v_add_u32 v38, 132352, v38
  s_lshl_b32 s35, s2, 7
  s_add_u32 s35, s35, 3276800
  v_lshl_add_u32 v48, v3, 4, s35
  v_lshlrev_b32 v51, 6, v4
  s_mov_b32 s38, 0
  s_lshr_b32 s56, s2, 6
  s_lshl_b32 s56, s56, 4
  s_and_b32 s36, s2, 15
  s_add_u32 s56, s56, s36
  s_sub_u32 s56, s56, 16
  s_cmp_ge_u32 s29, 6
  s_cselect_b32 s56, s56, 48
  s_cmp_lt_u32 s56, 48
  s_cselect_b32 s56, 2, 1
  s_add_u32 s40, s26, 3276800
  s_addc_u32 s41, s27, 0
  s_lshr_b32 s35, s2, 3
  v_readfirstlane_b32 s39, v51
  s_add_u32 s36, s35, 1
  s_and_b32 s36, s36, 31
  s_lshl_b32 s36, s36, 10
  s_add_u32 s64, s36, 0
  s_add_u32 s36, s35, 5
  s_and_b32 s36, s36, 31
  s_lshl_b32 s36, s36, 10
  s_add_u32 s65, s36, 128
  s_add_u32 s36, s35, 9
  s_and_b32 s36, s36, 31
  s_lshl_b32 s36, s36, 10
  s_add_u32 s66, s36, 256
  s_add_u32 s36, s35, 13
  s_and_b32 s36, s36, 31
  s_lshl_b32 s36, s36, 10
  s_add_u32 s67, s36, 384
  s_add_u32 s36, s35, 17
  s_and_b32 s36, s36, 31
  s_lshl_b32 s36, s36, 10
  s_add_u32 s68, s36, 512
  s_add_u32 s36, s35, 21
  s_and_b32 s36, s36, 31
  s_lshl_b32 s36, s36, 10
  s_add_u32 s69, s36, 640
  s_add_u32 s36, s35, 25
  s_and_b32 s36, s36, 31
  s_lshl_b32 s36, s36, 10
  s_add_u32 s70, s36, 768
  s_add_u32 s36, s35, 29
  s_and_b32 s36, s36, 31
  s_lshl_b32 s36, s36, 10
  s_add_u32 s71, s36, 896
  s_mov_b32 s95, 8000000
L_cp_23:
  s_sub_u32 s95, s95, 1
  s_cbranch_scc1 L_bc
  s_sleep 2
  ds_read_b32 v56, v38
  s_waitcnt lgkmcnt(0)
  s_nop 0
  v_add_u32_dpp v56, v56, v56 quad_perm:[1,0,3,2] row_mask:0xf bank_mask:0xf
  s_nop 1
  v_add_u32_dpp v56, v56, v56 quad_perm:[2,3,0,1] row_mask:0xf bank_mask:0xf
  s_nop 0
  v_cmp_gt_u32 vcc, 200, v56
  s_cbranch_vccnz L_cp_23
  v_add_u32 v52, 1, v51
  s_mov_b64 exec, 0xff
  global_store_dwordx4 v48, v[52:55], s[26:27] sc1
  s_mov_b64 exec, -1
  s_mov_b32 s35, 0
  s_load_dword s44, s[40:41], s64
  s_load_dword s45, s[40:41], s65
  s_load_dword s46, s[40:41], s66
  s_load_dword s47, s[40:41], s67
  s_load_dword s48, s[40:41], s68
  s_load_dword s49, s[40:41], s69
  s_load_dword s50, s[40:41], s70
  s_load_dword s51, s[40:41], s71
  s_waitcnt lgkmcnt(0)
  s_sub_u32 s44, s44, s39
  s_cmp_eq_u32 s44, 1
  s_addc_u32 s35, s35, 0
  s_sub_u32 s45, s45, s39
  s_cmp_eq_u32 s45, 1
  s_addc_u32 s35, s35, 0
  s_sub_u32 s46, s46, s39
  s_cmp_eq_u32 s46, 1
  s_addc_u32 s35, s35, 0
  s_sub_u32 s47, s47, s39
  s_cmp_eq_u32 s47, 1
  s_addc_u32 s35, s35, 0
  s_sub_u32 s48, s48, s39
  s_cmp_eq_u32 s48, 1
  s_addc_u32 s35, s35, 0
  s_sub_u32 s49, s49, s39
  s_cmp_eq_u32 s49, 1
  s_addc_u32 s35, s35, 0
  s_sub_u32 s50, s50, s39
  s_cmp_eq_u32 s50, 1
  s_addc_u32 s35, s35, 0
  s_sub_u32 s51, s51, s39
  s_cmp_eq_u32 s51, 1
  s_addc_u32 s35, s35, 0
  s_add_u32 s40, s40, 0x8000
  s_addc_u32 s41, s41, 0
  v_add_u32 v48, 0x8000, v48
  s_lshl_b32 s35, s35, 1
  s_sub_u32 s35, s35, 8
  s_mul_i32 s36, s35, 24
  s_cmp_gt_i32 s35, 0
  s_cselect_b32 s37, s56, 1
  s_mul_i32 s36, s36, s37
  s_ashr_i32 s38, s36, 4
  s_cmp_eq_u32 s35, 8
  s_cselect_b32 s37, 8, 0
  s_add_u32 s38, s38, s37
  s_add_u32 s36, s38, 22
  s_max_i32 s36, s36, 0
  s_min_i32 s36, s36, 80
  v_mov_b32 v56, s36
  ds_write_b32 v9, v56 offset:16
  s_mov_b32 s95, 8000000
L_cp_24:
  s_sub_u32 s95, s95, 1
  s_cbranch_scc1 L_bc
  s_sleep 2
  ds_read_b32 v56, v38
  s_waitcnt lgkmcnt(0)
  s_nop 0
  v_add_u32_dpp v56, v56, v56 quad_perm:[1,0,3,2] row_mask:0xf bank_mask:0xf
  s_nop 1
  v_add_u32_dpp v56, v56, v56 quad_perm:[2,3,0,1] row_mask:0xf bank_mask:0xf
  s_nop 0
  v_cmp_gt_u32 vcc, 336, v56
  s_cbranch_vccnz L_cp_24
  v_add_u32 v52, 2, v51
  s_mov_b64 exec, 0xff
  global_store_dwordx4 v48, v[52:55], s[26:27] sc1
  s_mov_b64 exec, -1
  s_mov_b32 s35, 0
  s_load_dword s44, s[40:41], s64
  s_load_dword s45, s[40:41], s65
  s_load_dword s46, s[40:41], s66
  s_load_dword s47, s[40:41], s67
  s_load_dword s48, s[40:41], s68
  s_load_dword s49, s[40:41], s69
  s_load_dword s50, s[40:41], s70
  s_load_dword s51, s[40:41], s71
  s_waitcnt lgkmcnt(0)
  s_sub_u32 s44, s44, s39
  s_cmp_eq_u32 s44, 2
  s_addc_u32 s35, s35, 0
  s_sub_u32 s45, s45, s39
  s_cmp_eq_u32 s45, 2
  s_addc_u32 s35, s35, 0
  s_sub_u32 s46, s46, s39
  s_cmp_eq_u32 s46, 2
  s_addc_u32 s35, s35, 0
  s_sub_u32 s47, s47, s39
  s_cmp_eq_u32 s47, 2
  s_addc_u32 s35, s35, 0
  s_sub_u32 s48, s48, s39
  s_cmp_eq_u32 s48, 2
  s_addc_u32 s35, s35, 0
  s_sub_u32 s49, s49, s39
  s_cmp_eq_u32 s49, 2
  s_addc_u32 s35, s35, 0
  s_sub_u32 s50, s50, s39
  s_cmp_eq_u32 s50, 2
  s_addc_u32 s35, s35, 0
  s_sub_u32 s51, s51, s39
  s_cmp_eq_u32 s51, 2
  s_addc_u32 s35, s35, 0
  s_add_u32 s40, s40, 0x8000
  s_addc_u32 s41, s41, 0
  v_add_u32 v48, 0x8000, v48
  s_lshl_b32 s35, s35, 1
  s_sub_u32 s35, s35, 8
  s_mul_i32 s36, s35, 36
  s_cmp_gt_i32 s35, 0
  s_cselect_b32 s37, s56, 1
  s_mul_i32 s36, s36, s37
  s_ashr_i32 s38, s36, 4
  s_cmp_eq_u32 s35, 8
  s_cselect_b32 s37, 8, 0
  s_add_u32 s38, s38, s37
  s_add_u32 s36, s38, 22
  s_max_i32 s36, s36, 0
  s_min_i32 s36, s36, 80
  v_mov_b32 v56, s36
  ds_write_b32 v9, v56 offset:16
  s_mov_b32 s95, 8000000
L_cp_25:
  s_sub_u32 s95, s95, 1
  s_cbranch_scc1 L_bc
  s_sleep 2
  ds_read_b32 v56, v38
  s_waitcnt lgkmcnt(0)
  s_nop 0
  v_add_u32_dpp v56, v56, v56 quad_perm:[1,0,3,2] row_mask:0xf bank_mask:0xf
  s_nop 1
  v_add_u32_dpp v56, v56, v56 quad_perm:[2,3,0,1] row_mask:0xf bank_mask:0xf
  s_nop 0
  v_cmp_gt_u32 vcc, 416, v56
  s_cbranch_vccnz L_cp_25
  v_add_u32 v52, 3, v51
  s_mov_b64 exec, 0xff
  global_store_dwordx4 v48, v[52:55], s[26:27] sc1
  s_mov_b64 exec, -1
  s_mov_b32 s35, 0
  s_load_dword s44, s[40:41], s64
  s_load_dword s45, s[40:41], s65
  s_load_dword s46, s[40:41], s66
  s_load_dword s47, s[40:41], s67
  s_load_dword s48, s[40:41], s68
  s_load_dword s49, s[40:41], s69
  s_load_dword s50, s[40:41], s70
  s_load_dword s51, s[40:41], s71
  s_waitcnt lgkmcnt(0)
  s_sub_u32 s44, s44, s39
  s_cmp_eq_u32 s44, 3
  s_addc_u32 s35, s35, 0
  s_sub_u32 s45, s45, s39
  s_cmp_eq_u32 s45, 3
  s_addc_u32 s35, s35, 0
  s_sub_u32 s46, s46, s39
  s_cmp_eq_u32 s46, 3
  s_addc_u32 s35, s35, 0
  s_sub_u32 s47, s47, s39
  s_cmp_eq_u32 s47, 3
  s_addc_u32 s35, s35, 0
  s_sub_u32 s48, s48, s39
  s_cmp_eq_u32 s48, 3
  s_addc_u32 s35, s35, 0
  s_sub_u32 s49, s49, s39
  s_cmp_eq_u32 s49, 3
  s_addc_u32 s35, s35, 0
  s_sub_u32 s50, s50, s39
  s_cmp_eq_u32 s50, 3
  s_addc_u32 s35, s35, 0
  s_sub_u32 s51, s51, s39
  s_cmp_eq_u32 s51, 3
  s_addc_u32 s35, s35, 0
  s_add_u32 s40, s40, 0x8000
  s_addc_u32 s41, s41, 0
  v_add_u32 v48, 0x8000, v48
  s_lshl_b32 s35, s35, 1
  s_sub_u32 s35, s35, 8
  s_mul_i32 s36, s35, 40
  s_cmp_gt_i32 s35, 0
  s_cselect_b32 s37, s56, 1
  s_mul_i32 s36, s36, s37
  s_ashr_i32 s38, s36, 4
  s_cmp_eq_u32 s35, 8
  s_cselect_b32 s37, 8, 0
  s_add_u32 s38, s38, s37
  s_add_u32 s36, s38, 22
  s_max_i32 s36, s36, 0
  s_min_i32 s36, s36, 80
  v_mov_b32 v56, s36
  ds_write_b32 v9, v56 offset:16
  s_mov_b32 s95, 8000000
L_cp_26:
  s_sub_u32 s95, s95, 1
  s_cbranch_scc1 L_bc
  s_sleep 2
  ds_read_b32 v56, v38
  s_waitcnt lgkmcnt(0)
  s_nop 0
  v_add_u32_dpp v56, v56, v56 quad_perm:[1,0,3,2] row_mask:0xf bank_mask:0xf
  s_nop 1
  v_add_u32_dpp v56, v56, v56 quad_perm:[2,3,0,1] row_mask:0xf bank_mask:0xf
  s_nop 0
  v_cmp_gt_u32 vcc, 448, v56
  s_cbranch_vccnz L_cp_26
  s_add_u32 s36, s38, 80
  s_max_i32 s36, s36, 0
  s_min_i32 s36, s36, 80
  v_mov_b32 v56, s36
  ds_write_b32 v9, v56 offset:16
  s_branch L_bc
L_w0:
  s_mov_b32 s95, 8000000
L_lw_27:
  s_sleep 32
  ds_read_b32 v30, v9 offset:8
  s_sub_u32 s95, s95, 1
  s_cbranch_scc1 L_lwx_28
  s_waitcnt lgkmcnt(0)
  v_cmp_gt_u32 vcc, 4, v30
  s_cbranch_vccnz L_lw_27
L_lwx_28:
  v_lshrrev_b32 v44, 5, v1
  v_lshlrev_b32 v38, 4, v44
  v_add_u32 v38, 103424, v38
  ds_read_b128 v[48:51], v38
  ds_read_b128 v[52:55], v38 offset:32
  v_lshlrev_b32 v38, 2, v1
  v_add_u32 v38, 130304, v38
  ds_read_b32 v56, v38 offset:0
  ds_read_b32 v60, v38 offset:256
  ds_read_b32 v57, v38 offset:512
  ds_read_b32 v61, v38 offset:768
  ds_read_b32 v58, v38 offset:1024
  ds_read_b32 v62, v38 offset:1280
  ds_read_b32 v59, v38 offset:1536
  ds_read_b32 v63, v38 offset:1792
  v_lshlrev_b32 v44, 2, v44
  v_add_u32 v44, 103552, v44
  v_lshlrev_b32 v45, 4, v19
  v_add_u32 v45, 103424, v45
  v_lshlrev_b32 v46, 2, v19
  v_add_u32 v46, 103552, v46
  s_waitcnt lgkmcnt(0)
  v_max3_f32 v64, v48, v49, v50
  v_max3_f32 v65, v52, v53, v54
  v_max_f32 v64, v64, v51
  v_max_f32 v65, v65, v55
  v_sub_f32 v48, v48, v64
  v_sub_f32 v49, v49, v64
  v_sub_f32 v50, v50, v64
  v_sub_f32 v51, v51, v64
  v_sub_f32 v52, v52, v65
  v_sub_f32 v53, v53, v65
  v_sub_f32 v54, v54, v65
  v_sub_f32 v55, v55, v65
  v_mul_f32 v48, s63, v48
  v_mul_f32 v49, s63, v49
  v_mul_f32 v50, s63, v50
  v_mul_f32 v51, s63, v51
  v_mul_f32 v52, s63, v52
  v_mul_f32 v53, s63, v53
  v_mul_f32 v54, s63, v54
  v_mul_f32 v55, s63, v55
  v_exp_f32 v48, v48
  v_exp_f32 v49, v49
  v_exp_f32 v50, v50
  v_exp_f32 v51, v51
  v_exp_f32 v52, v52
  v_exp_f32 v53, v53
  v_exp_f32 v54, v54
  v_exp_f32 v55, v55
  v_mul_f32 v66, v56, v48
  v_mul_f32 v67, v60, v52
  v_fmac_f32 v66, v57, v49
  v_fmac_f32 v67, v61, v53
  v_fmac_f32 v66, v58, v50
  v_fmac_f32 v67, v62, v54
  v_fmac_f32 v66, v59, v51
  v_fmac_f32 v67, v63, v55
  s_nop 0
  s_nop 0
  v_add_f32_dpp v66, v66, v66 quad_perm:[1,0,3,2] row_mask:0xf bank_mask:0xf
  v_add_f32_dpp v67, v67, v67 quad_perm:[1,0,3,2] row_mask:0xf bank_mask:0xf
  s_nop 0
  v_add_f32_dpp v66, v66, v66 quad_perm:[2,3,0,1] row_mask:0xf bank_mask:0xf
  v_add_f32_dpp v67, v67, v67 quad_perm:[2,3,0,1] row_mask:0xf bank_mask:0xf
  s_nop 0
  v_add_f32_dpp v66, v66, v66 row_half_mirror row_mask:0xf bank_mask:0xf
  v_add_f32_dpp v67, v67, v67 row_half_mirror row_mask:0xf bank_mask:0xf
  s_nop 0
  v_add_f32_dpp v66, v66, v66 row_mirror row_mask:0xf bank_mask:0xf
  v_add_f32_dpp v67, v67, v67 row_mirror row_mask:0xf bank_mask:0xf
  v_mov_b32 v68, v66
  v_mov_b32 v69, v67
  s_nop 0
  v_permlane16_swap_b32 v66, v68
  v_permlane16_swap_b32 v67, v69
  v_add_f32 v66, v66, v68
  v_add_f32 v67, v67, v69
  s_mov_b32 exec_lo, 1
  s_mov_b32 exec_hi, 1
  ds_write_b32 v44, v66
  ds_write_b32 v44, v67 offset:8
  s_mov_b64 exec, -1
  ds_read_b128 v[48:51], v45
  ds_read_b32 v53, v46
  s_lshl_b32 s35, s28, 10
  s_add_u32 s35, s35, 3538944
  v_lshl_add_u32 v38, v1, 4, s35
  s_lshl_b32 s36, s29, 7
  v_add_u32 v44, s36, v38
  v_mov_b32 v54, v4
  v_mov_b32 v55, v4
  s_waitcnt lgkmcnt(0)
  v_max3_f32 v52, v48, v49, v50
  v_max_f32 v52, v52, v51
  s_mov_b64 exec, 0xff
  global_store_dwordx4 v44, v[52:55], s[26:27] sc1
  s_mov_b64 exec, -1
  v_mov_b32 v30, 132352
  s_mov_b32 s95, 8000000
L_lw_29:
  s_sleep 8
  ds_read_b32 v47, v30 offset:0
  s_sub_u32 s95, s95, 1
  s_cbranch_scc1 L_lwx_30
  s_waitcnt lgkmcnt(0)
  v_cmp_gt_u32 vcc, 74, v47
  s_cbranch_vccnz L_lw_29
L_lwx_30:
  global_load_dwordx4 v[56:59], v38, s[26:27] sc1
  s_mov_b32 s68, 1000000
L_poll_31:
  s_waitcnt vmcnt(0)
  v_cmp_ne_u64 s[64:65], v[58:59], v[4:5]
  s_or_b64 s[66:67], s[64:65], s[64:65]
  s_cbranch_scc0 L_got_32
  s_sub_u32 s68, s68, 1
  s_cbranch_scc1 L_got_32
  s_sleep 16
  s_wqm_b64 exec, s[64:65]
  global_load_dwordx4 v[56:59], v38, s[26:27] sc1
  s_mov_b64 exec, -1
  s_branch L_poll_31
L_got_32:
  v_mov_b32 v60, v56
  s_nop 1
  v_max_f32_dpp v60, v60, v60 row_ror:8 row_mask:0xf bank_mask:0xf
  v_mov_b32 v61, v60
  s_nop 1
  v_permlane16_swap_b32 v60, v61
  v_max_f32 v60, v60, v61
  v_mov_b32 v61, v60
  s_nop 1
  v_permlane32_swap_b32 v60, v61
  v_max_f32 v60, v60, v61
  v_sub_f32 v56, v56, v60
  v_mul_f32 v56, s63, v56
  v_exp_f32 v56, v56
  v_sub_f32 v48, v48, v60
  v_sub_f32 v49, v49, v60
  v_sub_f32 v50, v50, v60
  v_sub_f32 v51, v51, v60
  v_mul_f32 v57, v57, v56
  s_nop 1
  v_add_f32_dpp v57, v57, v57 row_ror:8 row_mask:0xf bank_mask:0xf
  v_mov_b32 v61, v57
  s_nop 1
  v_permlane16_swap_b32 v57, v61
  v_add_f32 v57, v57, v61
  v_mov_b32 v61, v57
  s_nop 1
  v_permlane32_swap_b32 v57, v61
  v_add_f32 v57, v57, v61
  v_rcp_f32 v57, v57
  v_mul_f32 v48, s63, v48
  v_mul_f32 v49, s63, v49
  v_mul_f32 v50, s63, v50
  v_mul_f32 v51, s63, v51
  v_exp_f32 v48, v48
  v_exp_f32 v49, v49
  v_exp_f32 v50, v50
  v_exp_f32 v51, v51
  v_add_u32 v45, 144, v45
  v_mul_f32 v48, v48, v57
  v_mul_f32 v49, v49, v57
  v_mul_f32 v50, v50, v57
  v_mul_f32 v51, v51, v57
  s_mov_b64 exec, 15
  ds_write_b128 v45, v[48:51]
  s_mov_b64 exec, -1
  v_lshlrev_b32 v36, 4, v1
  v_add_u32 v36, 104192, v36
  v_mov_b32 v38, 103568
  s_mov_b32 s95, 8000000
L_lw_33:
  s_sleep 4
  ds_read_b32 v30, v9 offset:20
  s_sub_u32 s95, s95, 1
  s_cbranch_scc1 L_lwx_34
  s_waitcnt lgkmcnt(0)
  v_cmp_gt_u32 vcc, 12, v30
  s_cbranch_vccnz L_lw_33
L_lwx_34:
  ds_read_b128 v[96:99], v38
  s_waitcnt lgkmcnt(0)
  ds_read_b128 v[48:51], v36 offset:0
  ds_read_b128 v[52:55], v36 offset:768
  ds_read_b128 v[56:59], v36 offset:1536
  ds_read_b128 v[60:63], v36 offset:2304
  ds_read_b128 v[64:67], v36 offset:3072
  ds_read_b128 v[68:71], v36 offset:3840
  ds_read_b128 v[72:75], v36 offset:4608
  ds_read_b128 v[76:79], v36 offset:5376
  s_waitcnt lgkmcnt(6)
  v_pk_add_f32 v[48:49], v[48:49], v[52:53]
  v_pk_add_f32 v[50:51], v[50:51], v[54:55]
  v_pk_mul_f32 v[100:101], v[48:49], v[96:97] op_sel_hi:[1,0]
  v_pk_mul_f32 v[102:103], v[50:51], v[96:97] op_sel_hi:[1,0]
  s_waitcnt lgkmcnt(4)
  v_pk_add_f32 v[56:57], v[56:57], v[60:61]
  v_pk_add_f32 v[58:59], v[58:59], v[62:63]
  v_pk_fma_f32 v[100:101], v[56:57], v[96:97], v[100:101] op_sel:[0,1,0] op_sel_hi:[1,1,1]
  v_pk_fma_f32 v[102:103], v[58:59], v[96:97], v[102:103] op_sel:[0,1,0] op_sel_hi:[1,1,1]
  s_waitcnt lgkmcnt(2)
  v_pk_add_f32 v[64:65], v[64:65], v[68:69]
  v_pk_add_f32 v[66:67], v[66:67], v[70:71]
  v_pk_fma_f32 v[100:101], v[64:65], v[98:99], v[100:101] op_sel:[0,0,0] op_sel_hi:[1,0,1]
  v_pk_fma_f32 v[102:103], v[66:67], v[98:99], v[102:103] op_sel:[0,0,0] op_sel_hi:[1,0,1]
  s_waitcnt lgkmcnt(0)
  v_pk_add_f32 v[72:73], v[72:73], v[76:77]
  v_pk_add_f32 v[74:75], v[74:75], v[78:79]
  v_pk_fma_f32 v[100:101], v[72:73], v[98:99], v[100:101] op_sel:[0,1,0] op_sel_hi:[1,1,1]
  v_pk_fma_f32 v[102:103], v[74:75], v[98:99], v[102:103] op_sel:[0,1,0] op_sel_hi:[1,1,1]
  v_bfi_b32 v100, s59, v14, v100
  v_add_u32 v36, 6144, v36
  v_add_u32 v38, 16, v38
  ds_read_b128 v[96:99], v38
  s_waitcnt lgkmcnt(0)
  ds_read_b128 v[48:51], v36 offset:0
  ds_read_b128 v[52:55], v36 offset:768
  ds_read_b128 v[56:59], v36 offset:1536
  ds_read_b128 v[60:63], v36 offset:2304
  ds_read_b128 v[64:67], v36 offset:3072
  ds_read_b128 v[68:71], v36 offset:3840
  ds_read_b128 v[72:75], v36 offset:4608
  ds_read_b128 v[76:79], v36 offset:5376
  s_waitcnt lgkmcnt(6)
  v_pk_add_f32 v[48:49], v[48:49], v[52:53]
  v_pk_add_f32 v[50:51], v[50:51], v[54:55]
  v_pk_mul_f32 v[104:105], v[48:49], v[96:97] op_sel_hi:[1,0]
  v_pk_mul_f32 v[106:107], v[50:51], v[96:97] op_sel_hi:[1,0]
  s_waitcnt lgkmcnt(4)
  v_pk_add_f32 v[56:57], v[56:57], v[60:61]
  v_pk_add_f32 v[58:59], v[58:59], v[62:63]
  v_pk_fma_f32 v[104:105], v[56:57], v[96:97], v[104:105] op_sel:[0,1,0] op_sel_hi:[1,1,1]
  v_pk_fma_f32 v[106:107], v[58:59], v[96:97], v[106:107] op_sel:[0,1,0] op_sel_hi:[1,1,1]
  s_waitcnt lgkmcnt(2)
  v_pk_add_f32 v[64:65], v[64:65], v[68:69]
  v_pk_add_f32 v[66:67], v[66:67], v[70:71]
  v_pk_fma_f32 v[104:105], v[64:65], v[98:99], v[104:105] op_sel:[0,0,0] op_sel_hi:[1,0,1]
  v_pk_fma_f32 v[106:107], v[66:67], v[98:99], v[106:107] op_sel:[0,0,0] op_sel_hi:[1,0,1]
  s_waitcnt lgkmcnt(0)
  v_pk_add_f32 v[72:73], v[72:73], v[76:77]
  v_pk_add_f32 v[74:75], v[74:75], v[78:79]
  v_pk_fma_f32 v[104:105], v[72:73], v[98:99], v[104:105] op_sel:[0,1,0] op_sel_hi:[1,1,1]
  v_pk_fma_f32 v[106:107], v[74:75], v[98:99], v[106:107] op_sel:[0,1,0] op_sel_hi:[1,1,1]
  v_bfi_b32 v104, s59, v14, v104
  v_add_u32 v36, 6144, v36
  v_add_u32 v38, 16, v38
  ds_read_b128 v[96:99], v38
  s_waitcnt lgkmcnt(0)
  ds_read_b128 v[48:51], v36 offset:0
  ds_read_b128 v[52:55], v36 offset:768
  ds_read_b128 v[56:59], v36 offset:1536
  ds_read_b128 v[60:63], v36 offset:2304
  ds_read_b128 v[64:67], v36 offset:3072
  ds_read_b128 v[68:71], v36 offset:3840
  ds_read_b128 v[72:75], v36 offset:4608
  ds_read_b128 v[76:79], v36 offset:5376
  s_waitcnt lgkmcnt(6)
  v_pk_add_f32 v[48:49], v[48:49], v[52:53]
  v_pk_add_f32 v[50:51], v[50:51], v[54:55]
  v_pk_mul_f32 v[108:109], v[48:49], v[96:97] op_sel_hi:[1,0]
  v_pk_mul_f32 v[110:111], v[50:51], v[96:97] op_sel_hi:[1,0]
  s_waitcnt lgkmcnt(4)
  v_pk_add_f32 v[56:57], v[56:57], v[60:61]
  v_pk_add_f32 v[58:59], v[58:59], v[62:63]
  v_pk_fma_f32 v[108:109], v[56:57], v[96:97], v[108:109] op_sel:[0,1,0] op_sel_hi:[1,1,1]
  v_pk_fma_f32 v[110:111], v[58:59], v[96:97], v[110:111] op_sel:[0,1,0] op_sel_hi:[1,1,1]
  s_waitcnt lgkmcnt(2)
  v_pk_add_f32 v[64:65], v[64:65], v[68:69]
  v_pk_add_f32 v[66:67], v[66:67], v[70:71]
  v_pk_fma_f32 v[108:109], v[64:65], v[98:99], v[108:109] op_sel:[0,0,0] op_sel_hi:[1,0,1]
  v_pk_fma_f32 v[110:111], v[66:67], v[98:99], v[110:111] op_sel:[0,0,0] op_sel_hi:[1,0,1]
  s_waitcnt lgkmcnt(0)
  v_pk_add_f32 v[72:73], v[72:73], v[76:77]
  v_pk_add_f32 v[74:75], v[74:75], v[78:79]
  v_pk_fma_f32 v[108:109], v[72:73], v[98:99], v[108:109] op_sel:[0,1,0] op_sel_hi:[1,1,1]
  v_pk_fma_f32 v[110:111], v[74:75], v[98:99], v[110:111] op_sel:[0,1,0] op_sel_hi:[1,1,1]
  v_bfi_b32 v108, s59, v14, v108
  v_add_u32 v36, 6144, v36
  v_add_u32 v38, 16, v38
  v_mov_b32 v45, v33
  v_add_u32 v33, 6144, v33
  v_add_u32 v44, 6144, v33
  s_mov_b64 exec, s[54:55]
  global_store_dwordx4 v45, v[100:103], s[26:27] sc1
  global_store_dwordx4 v33, v[104:107], s[26:27] sc1
  global_store_dwordx4 v44, v[108:111], s[26:27] sc1
  s_mov_b64 exec, -1
  v_add_u32 v33, 6144, v44
  ds_read_b128 v[96:99], v38
  s_waitcnt lgkmcnt(0)
  s_barrier
  ds_read_b128 v[48:51], v36 offset:0
  ds_read_b128 v[52:55], v36 offset:768
  ds_read_b128 v[56:59], v36 offset:1536
  ds_read_b128 v[60:63], v36 offset:2304
  ds_read_b128 v[64:67], v36 offset:3072
  ds_read_b128 v[68:71], v36 offset:3840
  ds_read_b128 v[72:75], v36 offset:4608
  ds_read_b128 v[76:79], v36 offset:5376
  s_waitcnt lgkmcnt(6)
  v_pk_add_f32 v[48:49], v[48:49], v[52:53]
  v_pk_add_f32 v[50:51], v[50:51], v[54:55]
  v_pk_mul_f32 v[84:85], v[48:49], v[96:97] op_sel_hi:[1,0]
  v_pk_mul_f32 v[86:87], v[50:51], v[96:97] op_sel_hi:[1,0]
  s_waitcnt lgkmcnt(4)
  v_pk_add_f32 v[56:57], v[56:57], v[60:61]
  v_pk_add_f32 v[58:59], v[58:59], v[62:63]
  v_pk_fma_f32 v[84:85], v[56:57], v[96:97], v[84:85] op_sel:[0,1,0] op_sel_hi:[1,1,1]
  v_pk_fma_f32 v[86:87], v[58:59], v[96:97], v[86:87] op_sel:[0,1,0] op_sel_hi:[1,1,1]
  s_waitcnt lgkmcnt(2)
  v_pk_add_f32 v[64:65], v[64:65], v[68:69]
  v_pk_add_f32 v[66:67], v[66:67], v[70:71]
  v_pk_fma_f32 v[84:85], v[64:65], v[98:99], v[84:85] op_sel:[0,0,0] op_sel_hi:[1,0,1]
  v_pk_fma_f32 v[86:87], v[66:67], v[98:99], v[86:87] op_sel:[0,0,0] op_sel_hi:[1,0,1]
  s_waitcnt lgkmcnt(0)
  v_pk_add_f32 v[72:73], v[72:73], v[76:77]
  v_pk_add_f32 v[74:75], v[74:75], v[78:79]
  v_pk_fma_f32 v[84:85], v[72:73], v[98:99], v[84:85] op_sel:[0,1,0] op_sel_hi:[1,1,1]
  v_pk_fma_f32 v[86:87], v[74:75], v[98:99], v[86:87] op_sel:[0,1,0] op_sel_hi:[1,1,1]
  v_bfi_b32 v84, s59, v14, v84
  s_mov_b64 exec, s[54:55]
  global_store_dwordx4 v33, v[84:87], s[26:27] sc1
  s_mov_b64 exec, -1
  s_branch L_col
L_bc:
  s_barrier
  s_cmp_lt_u32 s33, 0
  s_cbranch_scc1 L_bd
L_col:
  s_mov_b32 s92, 0xffffffff
  s_mov_b32 s93, 0xffff
  s_mov_b64 exec, s[92:93]
  global_load_dwordx4 v[48:51], v34, s[26:27] offset:-2688 sc1
  global_load_dwordx4 v[52:55], v34, s[26:27] offset:-1920 sc1
  global_load_dwordx4 v[56:59], v34, s[26:27] offset:-1152 sc1
  global_load_dwordx4 v[60:63], v34, s[26:27] offset:-384 sc1
  global_load_dwordx4 v[64:67], v34, s[26:27] offset:384 sc1
  global_load_dwordx4 v[68:71], v34, s[26:27] offset:1152 sc1
  global_load_dwordx4 v[72:75], v34, s[26:27] offset:1920 sc1
  global_load_dwordx4 v[76:79], v34, s[26:27] offset:2688 sc1
  s_mov_b32 s82, 1000000
L_poll_35:
  s_waitcnt vmcnt(0)
  v_cmp_ne_u32_sdwa s[64:65], v48, v14 src0_sel:BYTE_0 src1_sel:BYTE_0
  v_cmp_ne_u32_sdwa s[66:67], v52, v14 src0_sel:BYTE_0 src1_sel:BYTE_0
  v_cmp_ne_u32_sdwa s[68:69], v56, v14 src0_sel:BYTE_0 src1_sel:BYTE_0
  v_cmp_ne_u32_sdwa s[70:71], v60, v14 src0_sel:BYTE_0 src1_sel:BYTE_0
  v_cmp_ne_u32_sdwa s[72:73], v64, v14 src0_sel:BYTE_0 src1_sel:BYTE_0
  v_cmp_ne_u32_sdwa s[74:75], v68, v14 src0_sel:BYTE_0 src1_sel:BYTE_0
  v_cmp_ne_u32_sdwa s[76:77], v72, v14 src0_sel:BYTE_0 src1_sel:BYTE_0
  v_cmp_ne_u32_sdwa s[78:79], v76, v14 src0_sel:BYTE_0 src1_sel:BYTE_0
  s_or_b64 s[80:81], s[64:65], s[66:67]
  s_or_b64 s[80:81], s[80:81], s[68:69]
  s_or_b64 s[80:81], s[80:81], s[70:71]
  s_or_b64 s[80:81], s[80:81], s[72:73]
  s_or_b64 s[80:81], s[80:81], s[74:75]
  s_or_b64 s[80:81], s[80:81], s[76:77]
  s_or_b64 s[80:81], s[80:81], s[78:79]
  s_cbranch_scc0 L_got_36
  s_sub_u32 s82, s82, 1
  s_cbranch_scc1 L_got_36
  s_sleep 1
  s_wqm_b64 exec, s[64:65]
  global_load_dwordx4 v[48:51], v34, s[26:27] offset:-2688 sc1
  s_wqm_b64 exec, s[66:67]
  global_load_dwordx4 v[52:55], v34, s[26:27] offset:-1920 sc1
  s_wqm_b64 exec, s[68:69]
  global_load_dwordx4 v[56:59], v34, s[26:27] offset:-1152 sc1
  s_wqm_b64 exec, s[70:71]
  global_load_dwordx4 v[60:63], v34, s[26:27] offset:-384 sc1
  s_wqm_b64 exec, s[72:73]
  global_load_dwordx4 v[64:67], v34, s[26:27] offset:384 sc1
  s_wqm_b64 exec, s[74:75]
  global_load_dwordx4 v[68:71], v34, s[26:27] offset:1152 sc1
  s_wqm_b64 exec, s[76:77]
  global_load_dwordx4 v[72:75], v34, s[26:27] offset:1920 sc1
  s_wqm_b64 exec, s[78:79]
  global_load_dwordx4 v[76:79], v34, s[26:27] offset:2688 sc1
  s_mov_b64 exec, s[92:93]
  s_branch L_poll_35
L_got_36:
  v_and_b32 v48, s90, v48
  v_and_b32 v52, s90, v52
  v_and_b32 v56, s90, v56
  v_and_b32 v60, s90, v60
  v_and_b32 v64, s90, v64
  v_and_b32 v68, s90, v68
  v_and_b32 v72, s90, v72
  v_and_b32 v76, s90, v76
  s_mov_b64 exec, -1
  v_pk_add_f32 v[48:49], v[48:49], v[52:53]
  v_pk_add_f32 v[50:51], v[50:51], v[54:55]
  v_pk_add_f32 v[56:57], v[56:57], v[60:61]
  v_pk_add_f32 v[58:59], v[58:59], v[62:63]
  v_pk_add_f32 v[64:65], v[64:65], v[68:69]
  v_pk_add_f32 v[66:67], v[66:67], v[70:71]
  v_pk_add_f32 v[72:73], v[72:73], v[76:77]
  v_pk_add_f32 v[74:75], v[74:75], v[78:79]
  v_pk_add_f32 v[48:49], v[48:49], v[56:57]
  v_pk_add_f32 v[50:51], v[50:51], v[58:59]
  v_pk_add_f32 v[64:65], v[64:65], v[72:73]
  v_pk_add_f32 v[66:67], v[66:67], v[74:75]
  v_pk_add_f32 v[48:49], v[48:49], v[64:65]
  v_pk_add_f32 v[50:51], v[50:51], v[66:67]
  v_cvt_pk_bf16_f32 v48, v48, v49
  v_cvt_pk_bf16_f32 v49, v50, v51
  s_mov_b64 exec, s[54:55]
  ds_write_b64 v37, v[48:49]
  s_mov_b64 exec, -1
L_bd:
  s_waitcnt lgkmcnt(0)
  s_barrier
  ds_read_b128 v[60:63], v39 offset:0
  ds_read_b128 v[64:67], v39 offset:64
  ds_read_b128 v[68:71], v39 offset:128
  ds_read_b128 v[72:75], v39 offset:192
  ds_read_b128 v[76:79], v39 offset:256
  ds_read_b128 v[80:83], v39 offset:320
  s_waitcnt lgkmcnt(5)
  v_mfma_f32_16x16x32_bf16 v[92:95], v[60:63], v[112:115], 0
  v_mfma_f32_16x16x32_bf16 v[96:99], v[60:63], v[136:139], 0
  s_waitcnt lgkmcnt(4)
  v_mfma_f32_16x16x32_bf16 v[92:95], v[64:67], v[116:119], v[92:95]
  v_mfma_f32_16x16x32_bf16 v[96:99], v[64:67], v[140:143], v[96:99]
  s_waitcnt lgkmcnt(3)
  v_mfma_f32_16x16x32_bf16 v[92:95], v[68:71], v[120:123], v[92:95]
  v_mfma_f32_16x16x32_bf16 v[96:99], v[68:71], v[144:147], v[96:99]
  s_waitcnt lgkmcnt(2)
  v_mfma_f32_16x16x32_bf16 v[92:95], v[72:75], v[124:127], v[92:95]
  v_mfma_f32_16x16x32_bf16 v[96:99], v[72:75], v[148:151], v[96:99]
  s_waitcnt lgkmcnt(1)
  v_mfma_f32_16x16x32_bf16 v[92:95], v[76:79], v[128:131], v[92:95]
  v_mfma_f32_16x16x32_bf16 v[96:99], v[76:79], v[152:155], v[96:99]
  s_waitcnt lgkmcnt(0)
  v_mfma_f32_16x16x32_bf16 v[92:95], v[80:83], v[132:135], v[92:95]
  v_mfma_f32_16x16x32_bf16 v[96:99], v[80:83], v[156:159], v[96:99]
  s_mov_b64 exec, 0xffff
  s_nop 5
  v_bfi_b32 v92, s59, v14, v92
  v_bfi_b32 v96, s59, v14, v96
  global_store_dwordx4 v31, v[92:95], s[26:27] sc1
  s_cmp_lg_u32 s33, 0
  s_cbranch_scc1 L_not4
  global_store_dwordx4 v32, v[96:99], s[26:27] sc1
L_not4:
  s_mov_b64 exec, -1
  s_cmp_lg_u32 s33, 3
  s_cbranch_scc1 L_fini
  s_cmp_ge_u32 s2, 40
  s_cbranch_scc1 L_fini
  global_load_dwordx4 v[48:51], v40, s[26:27] offset:-4096 sc1
  global_load_dwordx4 v[52:55], v40, s[26:27] offset:-3072 sc1
  global_load_dwordx4 v[56:59], v40, s[26:27] offset:-2048 sc1
  global_load_dwordx4 v[60:63], v40, s[26:27] offset:-1024 sc1
  global_load_dwordx4 v[64:67], v40, s[26:27] offset:0 sc1
  global_load_dwordx4 v[68:71], v40, s[26:27] offset:1024 sc1
  global_load_dwordx4 v[72:75], v40, s[26:27] offset:2048 sc1
  global_load_dwordx4 v[76:79], v40, s[26:27] offset:3072 sc1
  s_mov_b32 s82, 1000000
L_poll_37:
  s_waitcnt vmcnt(0)
  v_cmp_ne_u32_sdwa s[64:65], v48, v14 src0_sel:BYTE_0 src1_sel:BYTE_0
  v_cmp_ne_u32_sdwa s[66:67], v52, v14 src0_sel:BYTE_0 src1_sel:BYTE_0
  v_cmp_ne_u32_sdwa s[68:69], v56, v14 src0_sel:BYTE_0 src1_sel:BYTE_0
  v_cmp_ne_u32_sdwa s[70:71], v60, v14 src0_sel:BYTE_0 src1_sel:BYTE_0
  v_cmp_ne_u32_sdwa s[72:73], v64, v14 src0_sel:BYTE_0 src1_sel:BYTE_0
  v_cmp_ne_u32_sdwa s[74:75], v68, v14 src0_sel:BYTE_0 src1_sel:BYTE_0
  v_cmp_ne_u32_sdwa s[76:77], v72, v14 src0_sel:BYTE_0 src1_sel:BYTE_0
  v_cmp_ne_u32_sdwa s[78:79], v76, v14 src0_sel:BYTE_0 src1_sel:BYTE_0
  s_or_b64 s[80:81], s[64:65], s[66:67]
  s_or_b64 s[80:81], s[80:81], s[68:69]
  s_or_b64 s[80:81], s[80:81], s[70:71]
  s_or_b64 s[80:81], s[80:81], s[72:73]
  s_or_b64 s[80:81], s[80:81], s[74:75]
  s_or_b64 s[80:81], s[80:81], s[76:77]
  s_or_b64 s[80:81], s[80:81], s[78:79]
  s_cbranch_scc0 L_got_38
  s_sub_u32 s82, s82, 1
  s_cbranch_scc1 L_got_38
  s_sleep 1
  s_wqm_b64 exec, s[64:65]
  global_load_dwordx4 v[48:51], v40, s[26:27] offset:-4096 sc1
  s_wqm_b64 exec, s[66:67]
  global_load_dwordx4 v[52:55], v40, s[26:27] offset:-3072 sc1
  s_wqm_b64 exec, s[68:69]
  global_load_dwordx4 v[56:59], v40, s[26:27] offset:-2048 sc1
  s_wqm_b64 exec, s[70:71]
  global_load_dwordx4 v[60:63], v40, s[26:27] offset:-1024 sc1
  s_wqm_b64 exec, s[72:73]
  global_load_dwordx4 v[64:67], v40, s[26:27] offset:0 sc1
  s_wqm_b64 exec, s[74:75]
  global_load_dwordx4 v[68:71], v40, s[26:27] offset:1024 sc1
  s_wqm_b64 exec, s[76:77]
  global_load_dwordx4 v[72:75], v40, s[26:27] offset:2048 sc1
  s_wqm_b64 exec, s[78:79]
  global_load_dwordx4 v[76:79], v40, s[26:27] offset:3072 sc1
  s_mov_b64 exec, -1
  s_branch L_poll_37
L_got_38:
  v_and_b32 v48, s90, v48
  v_and_b32 v52, s90, v52
  v_and_b32 v56, s90, v56
  v_and_b32 v60, s90, v60
  v_and_b32 v64, s90, v64
  v_and_b32 v68, s90, v68
  v_and_b32 v72, s90, v72
  v_and_b32 v76, s90, v76
  v_pk_add_f32 v[48:49], v[48:49], v[52:53]
  v_pk_add_f32 v[50:51], v[50:51], v[54:55]
  v_pk_add_f32 v[56:57], v[56:57], v[60:61]
  v_pk_add_f32 v[58:59], v[58:59], v[62:63]
  v_pk_add_f32 v[64:65], v[64:65], v[68:69]
  v_pk_add_f32 v[66:67], v[66:67], v[70:71]
  v_pk_add_f32 v[72:73], v[72:73], v[76:77]
  v_pk_add_f32 v[74:75], v[74:75], v[78:79]
  v_pk_add_f32 v[48:49], v[48:49], v[56:57]
  v_pk_add_f32 v[50:51], v[50:51], v[58:59]
  v_pk_add_f32 v[64:65], v[64:65], v[72:73]
  v_pk_add_f32 v[66:67], v[66:67], v[74:75]
  v_pk_add_f32 v[48:49], v[48:49], v[64:65]
  v_pk_add_f32 v[50:51], v[50:51], v[66:67]
  s_nop 1
  v_permlane16_swap_b32 v48, v49
  v_permlane16_swap_b32 v50, v51
  v_add_f32 v48, v48, v49
  v_add_f32 v50, v50, v51
  s_nop 1
  v_permlane32_swap_b32 v48, v50
  v_add_f32 v48, v48, v50
  v_cvt_pk_bf16_f32 v48, v48, v48
  v_and_b32 v48, s60, v48
  v_mul_f32 v48, v48, v42
  v_cvt_pk_bf16_f32 v48, v48, v48
  v_and_b32 v48, s60, v48
  v_add_f32 v48, v48, v43
  v_cvt_pk_bf16_f32 v48, v48, v48
  global_store_short v41, v48, s[22:23] sc1
  s_cmp_lg_u32 s2, 0
  s_cbranch_scc1 L_fini
  s_mov_b64 exec, 1
  global_store_dword v7, v4, s[26:27] sc1
L_fini:
L_end:
  s_endpgm
L_main:
  s_mul_i32 s32, s28, 1572864
  s_mul_i32 s33, s29, 49152
  s_add_u32 s32, s32, s33
  s_mul_i32 s33, s3, 12288
  s_add_u32 s32, s32, s33
  v_mul_u32_u24 v12, 384, v2
  v_lshl_add_u32 v12, v3, 4, v12
  v_add_u32 v12, s32, v12
  v_lshrrev_b32 v68, 5, v1
  v_bfe_u32 v69, v1, 2, 2
  v_lshl_add_u32 v70, v68, 2, v69
  v_mul_u32_u24 v4, 384, v70
  v_bfe_u32 v70, v1, 4, 1
  v_and_b32 v71, 3, v1
  v_lshlrev_b32 v71, 4, v71
  v_lshl_add_u32 v71, v70, 6, v71
  v_add3_u32 v4, v4, v71, s32
  v_add_u32 v71, 93184, v71
  v_cmp_eq_u32 s[66:67], v68, v69
  v_mov_b32 v19, 94720
  v_add_u32 v5, 3072, v4
  v_add_u32 v13, 3072, v12
  v_add_u32 v6, 6144, v4
  v_add_u32 v14, 6144, v12
  v_add_u32 v7, 9216, v4
  v_add_u32 v15, 9216, v12
  v_cndmask_b32 v19, v19, v71, s[66:67]
  s_min_u32 s65, s2, 239
  s_mul_i32 s64, s65, 205
  s_lshr_b32 s64, s64, 11
  s_mul_i32 s68, s64, 10
  s_sub_u32 s65, s65, s68
  v_mul_u32_u24 v73, 1280, v2
  v_lshl_add_u32 v73, v3, 4, v73
  s_mul_i32 s70, s64, 81920
  s_lshl_b32 s69, s65, 7
  s_add_u32 s70, s70, s69
  s_mul_i32 s69, s3, 20480
  s_add_u32 s70, s70, s69
  s_lshl_b32 s69, s3, 11
  s_mov_b32 s38, 201326592
  s_mov_b32 s39, 0x20000
  s_mov_b32 s42, 201326592
  s_mov_b32 s43, 0x20000
  s_mov_b32 s74, 201326592
  s_mov_b32 s75, 0x20000
  s_mov_b32 s58, 1966080
  s_mov_b32 s59, 0x20000
  s_mov_b32 s46, 7864320
  s_mov_b32 s47, 0x20000
  v_mul_u32_u24 v18, 205, v1
  v_lshrrev_b32 v18, 11, v18
  v_mul_u32_u24 v74, 10, v18
  v_sub_u32 v74, v1, v74
  v_mul_u32_u24 v18, 1280, v18
  v_lshl_add_u32 v18, v74, 4, v18
  s_mul_i32 s60, s28, 245760
  s_mul_i32 s61, s29, 160
  s_add_u32 s60, s60, s61
  s_mul_i32 s61, s3, 61440
  s_add_u32 s60, s60, s61
  s_mul_i32 s61, s3, 7680
  s_lshr_b32 s35, s28, 2
  s_mul_i32 s35, s35, 0
  s_mul_i32 s77, s28, 1
  s_add_u32 s77, s77, s35
  s_and_b32 s34, s77, 3
  s_mul_i32 s34, s34, 393216
  s_add_u32 s71, s77, 3
  s_and_b32 s71, s71, 3
  s_mul_i32 s71, s71, 393216
  s_add_u32 s71, s71, 150994944
  s_waitcnt lgkmcnt(0)
  s_mov_b32 s44, s12
  s_mov_b32 s45, s13
  s_mov_b32 s56, s20
  s_mov_b32 s57, s21
  s_mov_b32 s36, s6
  s_mov_b32 s37, s7
  s_mov_b32 s40, s6
  s_mov_b32 s41, s7
  s_mov_b32 s72, s8
  s_mov_b32 s73, s9
  s_barrier
  s_mov_b32 exec_hi, 0x0fffffff
  s_add_u32 m0, s61, 40960
  s_nop 0
  buffer_load_dwordx4 v18, s[44:47], s60 offen nt lds
  s_add_u32 m0, s61, 41920
  s_add_u32 s60, s60, 7680
  buffer_load_dwordx4 v18, s[44:47], s60 offen nt lds
  s_add_u32 m0, s61, 42880
  s_add_u32 s60, s60, 7680
  buffer_load_dwordx4 v18, s[44:47], s60 offen nt lds
  s_add_u32 m0, s61, 43840
  s_add_u32 s60, s60, 7680
  buffer_load_dwordx4 v18, s[44:47], s60 offen nt lds
  s_add_u32 m0, s61, 44800
  s_add_u32 s60, s60, 7680
  buffer_load_dwordx4 v18, s[44:47], s60 offen nt lds
  s_add_u32 m0, s61, 45760
  s_add_u32 s60, s60, 7680
  buffer_load_dwordx4 v18, s[44:47], s60 offen nt lds
  s_add_u32 m0, s61, 46720
  s_add_u32 s60, s60, 7680
  buffer_load_dwordx4 v18, s[44:47], s60 offen nt lds
  s_add_u32 m0, s61, 47680
  s_add_u32 s60, s60, 7680
  buffer_load_dwordx4 v18, s[44:47], s60 offen nt lds
  s_mov_b32 exec_hi, -1
  s_cmp_ge_u32 s2, 240
  s_cbranch_scc1 L_nowd
  s_add_u32 m0, s69, 79872
  s_nop 0
  s_waitcnt vmcnt(7)
  buffer_load_dwordx4 v73, s[56:59], s70 offen nt lds
  s_add_u32 m0, s69, 80896
  s_add_u32 s70, s70, 10240
  s_waitcnt vmcnt(7)
  buffer_load_dwordx4 v73, s[56:59], s70 offen nt lds
L_nowd:
  s_waitcnt vmcnt(7)
  buffer_load_dwordx4 v[80:83], v4, s[36:39], s34 offen offset:0 nt
  v_mov_b32 v8, v4
  v_mov_b32 v9, v5
  v_mov_b32 v10, v6
  v_mov_b32 v11, v7
  s_lshl_b32 s33, s3, 11
  s_add_u32 s33, s33, 95232
  v_lshl_add_u32 v17, v2, 4, s33
  v_bfe_u32 v68, v1, 2, 1
  v_lshrrev_b32 v69, 4, v1
  v_lshl_add_u32 v68, v68, 2, v69
  v_lshl_add_u32 v16, v68, 4, s33
  v_lshrrev_b32 v68, 1, v3
  v_and_b32 v69, 1, v3
  v_lshlrev_b32 v69, 4, v69
  v_mov_b32 v70, 0xffff
  v_lshlrev_b32 v69, v69, v70
  v_cmp_eq_u32 vcc, 0, v68
  v_mov_b32 v36, 0
  v_mov_b32 v37, 0
  v_cndmask_b32 v20, 0, v69, vcc
  v_cmp_eq_u32 vcc, 1, v68
  v_mov_b32 v38, 0
  v_mov_b32 v39, 0
  v_cndmask_b32 v21, 0, v69, vcc
  v_cmp_eq_u32 vcc, 2, v68
  v_mov_b32 v40, 0
  v_mov_b32 v41, 0
  v_cndmask_b32 v22, 0, v69, vcc
  v_cmp_eq_u32 vcc, 3, v68
  v_mov_b32 v42, 0
  v_mov_b32 v43, 0
  v_cndmask_b32 v23, 0, v69, vcc
  v_mov_b32 v44, 0
  v_mov_b32 v45, 0
  v_mov_b32 v46, 0
  v_mov_b32 v47, 0
  v_mov_b32 v129, 103504
  v_mov_b32 v130, 0
  s_lshl_b32 s84, s3, 8
  s_add_u32 s84, s84, 132352
  v_lshl_add_u32 v131, v1, 2, s84
  v_mov_b32 v18, 384
  v_cndmask_b32 v18, 0, v18, s[66:67]
  s_lshl_b32 s85, s3, 2
  s_mov_b32 s46, 0
  s_mov_b32 s62, 0x00110011
  s_mov_b32 s63, 0x00110011
  s_waitcnt vmcnt(7)
  buffer_load_dwordx4 v[84:87], v4, s[36:39], s34 offen offset:128 nt
  s_waitcnt vmcnt(7)
  buffer_load_dwordx4 v[88:91], v4, s[36:39], s34 offen offset:256 nt
  s_waitcnt vmcnt(7)
  buffer_load_dwordx4 v[92:95], v5, s[36:39], s34 offen offset:0 nt
  s_waitcnt vmcnt(7)
  buffer_load_dwordx4 v[96:99], v5, s[36:39], s34 offen offset:128 nt
  s_waitcnt vmcnt(7)
  buffer_load_dwordx4 v[100:103], v5, s[36:39], s34 offen offset:256 nt
  s_waitcnt vmcnt(7)
  buffer_load_dwordx4 v[104:107], v6, s[36:39], s34 offen offset:0 nt
  s_waitcnt vmcnt(7)
  buffer_load_dwordx4 v[108:111], v6, s[36:39], s34 offen offset:128 nt
  s_waitcnt vmcnt(7)
  buffer_load_dwordx4 v[112:115], v6, s[36:39], s34 offen offset:256 nt
  s_waitcnt vmcnt(7)
  buffer_load_dwordx4 v[116:119], v7, s[36:39], s34 offen offset:0 nt
  s_waitcnt vmcnt(7)
  buffer_load_dwordx4 v[120:123], v7, s[36:39], s34 offen offset:128 nt
  s_waitcnt vmcnt(7)
  buffer_load_dwordx4 v[132:135], v12, s[72:75], s71 offen offset:0 nt
  s_waitcnt vmcnt(7)
  buffer_load_dwordx4 v[136:139], v12, s[72:75], s71 offen offset:128 nt
  s_waitcnt vmcnt(7)
  buffer_load_dwordx4 v[140:143], v12, s[72:75], s71 offen offset:256 nt
  s_waitcnt vmcnt(7)
  buffer_load_dwordx4 v[144:147], v13, s[72:75], s71 offen offset:0 nt
  s_waitcnt vmcnt(7)
  buffer_load_dwordx4 v[148:151], v13, s[72:75], s71 offen offset:128 nt
  s_waitcnt vmcnt(7)
  buffer_load_dwordx4 v[152:155], v13, s[72:75], s71 offen offset:256 nt
  v_mov_b32 v68, 1
  s_mov_b64 exec, 1
  ds_add_u32 v129, v68 offset:8
  s_mov_b64 exec, -1
  s_barrier
  ds_read_b128 v[24:27], v19 offset:0
  ds_read_b128 v[28:31], v19 offset:128
  ds_read_b128 v[32:35], v19 offset:256
  ds_read_b32 v128, v129
L_kloop:
  s_add_u32 s86, s46, 1
  s_bfe_u32 s87, s86, 0x20002
  s_mul_i32 s87, s87, 50331648
  s_add_u32 s86, s86, s77
  s_and_b32 s86, s86, 3
  s_mul_i32 s86, s86, 393216
  s_add_u32 s35, s86, s87
  s_cmp_eq_u32 s46, 15
  s_cbranch_scc0 L_knl
  s_mov_b32 s40, s8
  s_mov_b32 s41, s9
  v_mov_b32 v8, v12
  v_mov_b32 v9, v13
  v_mov_b32 v10, v14
  v_mov_b32 v11, v15
L_knl:
  s_waitcnt lgkmcnt(0)
  v_readfirstlane_b32 s84, v128
  s_add_u32 s85, s85, s84
  s_lshr_b32 s84, s85, 4
  s_and_b32 s85, s85, 15
  s_cmp_eq_u32 s84, 1
  s_cbranch_scc1 L_kb_1
  s_cmp_eq_u32 s84, 2
  s_cbranch_scc1 L_kb_2
  s_cmp_eq_u32 s84, 3
  s_cbranch_scc1 L_kb_3
  s_cmp_eq_u32 s84, 4
  s_cbranch_scc1 L_kb_4
  s_cmp_eq_u32 s84, 5
  s_cbranch_scc1 L_kb_5
L_kb_0:
  s_waitcnt vmcnt(3)
  buffer_load_dwordx4 v[124:127], v7, s[36:39], s34 offen offset:256 nt
  v_mfma_f32_16x16x32_bf16 v[48:51], v[80:83], v[24:27], 0
  s_waitcnt vmcnt(3)
  buffer_load_dwordx4 v[80:83], v8, s[40:43], s35 offen offset:0 nt
  v_mfma_f32_16x16x32_bf16 v[48:51], v[84:87], v[28:31], v[48:51]
  s_waitcnt vmcnt(3)
  buffer_load_dwordx4 v[84:87], v8, s[40:43], s35 offen offset:128 nt
  v_mfma_f32_16x16x32_bf16 v[48:51], v[88:91], v[32:35], v[48:51]
  v_add_u32 v130, 1, v130
  ds_write_b32 v131, v130
  s_waitcnt vmcnt(3)
  buffer_load_dwordx4 v[88:91], v8, s[40:43], s35 offen offset:256 nt
  v_mfma_f32_16x16x32_bf16 v[52:55], v[92:95], v[24:27], 0
  s_waitcnt vmcnt(3)
  buffer_load_dwordx4 v[92:95], v9, s[40:43], s35 offen offset:0 nt
  v_mfma_f32_16x16x32_bf16 v[52:55], v[96:99], v[28:31], v[52:55]
  s_waitcnt vmcnt(3)
  buffer_load_dwordx4 v[96:99], v9, s[40:43], s35 offen offset:128 nt
  v_mfma_f32_16x16x32_bf16 v[52:55], v[100:103], v[32:35], v[52:55]
  v_add_f32_dpp v64, v49, v48 quad_perm:[1,1,1,1] row_mask:0xf bank_mask:0xf
  v_add_f32_dpp v64, v50, v64 quad_perm:[2,2,2,2] row_mask:0xf bank_mask:0xf
  v_add_f32_dpp v64, v51, v64 quad_perm:[3,3,3,3] row_mask:0xf bank_mask:0xf
  v_add_u32 v130, 1, v130
  ds_write_b32 v131, v130
  s_waitcnt vmcnt(3)
  buffer_load_dwordx4 v[100:103], v9, s[40:43], s35 offen offset:256 nt
  v_mfma_f32_16x16x32_bf16 v[48:51], v[104:107], v[24:27], 0
  s_waitcnt vmcnt(3)
  buffer_load_dwordx4 v[104:107], v10, s[40:43], s35 offen offset:0 nt
  v_mfma_f32_16x16x32_bf16 v[48:51], v[108:111], v[28:31], v[48:51]
  s_waitcnt vmcnt(3)
  buffer_load_dwordx4 v[108:111], v10, s[40:43], s35 offen offset:128 nt
  v_mfma_f32_16x16x32_bf16 v[48:51], v[112:115], v[32:35], v[48:51]
  v_add_f32_dpp v65, v53, v52 quad_perm:[1,1,1,1] row_mask:0xf bank_mask:0xf
  v_add_f32_dpp v65, v54, v65 quad_perm:[2,2,2,2] row_mask:0xf bank_mask:0xf
  v_add_f32_dpp v65, v55, v65 quad_perm:[3,3,3,3] row_mask:0xf bank_mask:0xf
  v_add_u32 v130, 1, v130
  ds_write_b32 v131, v130
  s_waitcnt vmcnt(3)
  buffer_load_dwordx4 v[112:115], v10, s[40:43], s35 offen offset:256 nt
  v_mfma_f32_16x16x32_bf16 v[52:55], v[116:119], v[24:27], 0
  s_waitcnt vmcnt(3)
  buffer_load_dwordx4 v[116:119], v11, s[40:43], s35 offen offset:0 nt
  v_mfma_f32_16x16x32_bf16 v[52:55], v[120:123], v[28:31], v[52:55]
  s_waitcnt vmcnt(3)
  buffer_load_dwordx4 v[120:123], v11, s[40:43], s35 offen offset:128 nt
  v_mfma_f32_16x16x32_bf16 v[52:55], v[124:127], v[32:35], v[52:55]
  v_add_f32_dpp v66, v49, v48 quad_perm:[1,1,1,1] row_mask:0xf bank_mask:0xf
  v_add_f32_dpp v66, v50, v66 quad_perm:[2,2,2,2] row_mask:0xf bank_mask:0xf
  v_add_f32_dpp v66, v51, v66 quad_perm:[3,3,3,3] row_mask:0xf bank_mask:0xf
  s_branch L_ktail
L_kb_1:
  s_waitcnt vmcnt(4)
  buffer_load_dwordx4 v[124:127], v7, s[36:39], s34 offen offset:256 nt
  v_mfma_f32_16x16x32_bf16 v[48:51], v[80:83], v[24:27], 0
  s_waitcnt vmcnt(4)
  buffer_load_dwordx4 v[80:83], v8, s[40:43], s35 offen offset:0 nt
  v_mfma_f32_16x16x32_bf16 v[48:51], v[84:87], v[28:31], v[48:51]
  s_waitcnt vmcnt(4)
  buffer_load_dwordx4 v[84:87], v8, s[40:43], s35 offen offset:128 nt
  v_mfma_f32_16x16x32_bf16 v[48:51], v[88:91], v[32:35], v[48:51]
  v_add_u32 v130, 1, v130
  ds_write_b32 v131, v130
  s_waitcnt vmcnt(4)
  buffer_load_dwordx4 v[88:91], v8, s[40:43], s35 offen offset:256 nt
  v_mfma_f32_16x16x32_bf16 v[52:55], v[92:95], v[24:27], 0
  s_waitcnt vmcnt(4)
  buffer_load_dwordx4 v[92:95], v9, s[40:43], s35 offen offset:0 nt
  v_mfma_f32_16x16x32_bf16 v[52:55], v[96:99], v[28:31], v[52:55]
  s_waitcnt vmcnt(4)
  buffer_load_dwordx4 v[96:99], v9, s[40:43], s35 offen offset:128 nt
  v_mfma_f32_16x16x32_bf16 v[52:55], v[100:103], v[32:35], v[52:55]
  v_add_f32_dpp v64, v49, v48 quad_perm:[1,1,1,1] row_mask:0xf bank_mask:0xf
  v_add_f32_dpp v64, v50, v64 quad_perm:[2,2,2,2] row_mask:0xf bank_mask:0xf
  v_add_f32_dpp v64, v51, v64 quad_perm:[3,3,3,3] row_mask:0xf bank_mask:0xf
  v_add_u32 v130, 1, v130
  ds_write_b32 v131, v130
  s_waitcnt vmcnt(4)
  buffer_load_dwordx4 v[100:103], v9, s[40:43], s35 offen offset:256 nt
  v_mfma_f32_16x16x32_bf16 v[48:51], v[104:107], v[24:27], 0
  s_waitcnt vmcnt(4)
  buffer_load_dwordx4 v[104:107], v10, s[40:43], s35 offen offset:0 nt
  v_mfma_f32_16x16x32_bf16 v[48:51], v[108:111], v[28:31], v[48:51]
  s_waitcnt vmcnt(4)
  buffer_load_dwordx4 v[108:111], v10, s[40:43], s35 offen offset:128 nt
  v_mfma_f32_16x16x32_bf16 v[48:51], v[112:115], v[32:35], v[48:51]
  v_add_f32_dpp v65, v53, v52 quad_perm:[1,1,1,1] row_mask:0xf bank_mask:0xf
  v_add_f32_dpp v65, v54, v65 quad_perm:[2,2,2,2] row_mask:0xf bank_mask:0xf
  v_add_f32_dpp v65, v55, v65 quad_perm:[3,3,3,3] row_mask:0xf bank_mask:0xf
  v_add_u32 v130, 1, v130
  ds_write_b32 v131, v130
  s_waitcnt vmcnt(4)
  buffer_load_dwordx4 v[112:115], v10, s[40:43], s35 offen offset:256 nt
  v_mfma_f32_16x16x32_bf16 v[52:55], v[116:119], v[24:27], 0
  s_waitcnt vmcnt(4)
  buffer_load_dwordx4 v[116:119], v11, s[40:43], s35 offen offset:0 nt
  v_mfma_f32_16x16x32_bf16 v[52:55], v[120:123], v[28:31], v[52:55]
  s_waitcnt vmcnt(4)
  buffer_load_dwordx4 v[120:123], v11, s[40:43], s35 offen offset:128 nt
  v_mfma_f32_16x16x32_bf16 v[52:55], v[124:127], v[32:35], v[52:55]
  v_add_f32_dpp v66, v49, v48 quad_perm:[1,1,1,1] row_mask:0xf bank_mask:0xf
  v_add_f32_dpp v66, v50, v66 quad_perm:[2,2,2,2] row_mask:0xf bank_mask:0xf
  v_add_f32_dpp v66, v51, v66 quad_perm:[3,3,3,3] row_mask:0xf bank_mask:0xf
  s_branch L_ktail
L_kb_2:
  s_waitcnt vmcnt(5)
  buffer_load_dwordx4 v[124:127], v7, s[36:39], s34 offen offset:256 nt
  v_mfma_f32_16x16x32_bf16 v[48:51], v[80:83], v[24:27], 0
  s_waitcnt vmcnt(5)
  buffer_load_dwordx4 v[80:83], v8, s[40:43], s35 offen offset:0 nt
  v_mfma_f32_16x16x32_bf16 v[48:51], v[84:87], v[28:31], v[48:51]
  s_waitcnt vmcnt(5)
  buffer_load_dwordx4 v[84:87], v8, s[40:43], s35 offen offset:128 nt
  v_mfma_f32_16x16x32_bf16 v[48:51], v[88:91], v[32:35], v[48:51]
  v_add_u32 v130, 1, v130
  ds_write_b32 v131, v130
  s_waitcnt vmcnt(5)
  buffer_load_dwordx4 v[88:91], v8, s[40:43], s35 offen offset:256 nt
  v_mfma_f32_16x16x32_bf16 v[52:55], v[92:95], v[24:27], 0
  s_waitcnt vmcnt(5)
  buffer_load_dwordx4 v[92:95], v9, s[40:43], s35 offen offset:0 nt
  v_mfma_f32_16x16x32_bf16 v[52:55], v[96:99], v[28:31], v[52:55]
  s_waitcnt vmcnt(5)
  buffer_load_dwordx4 v[96:99], v9, s[40:43], s35 offen offset:128 nt
  v_mfma_f32_16x16x32_bf16 v[52:55], v[100:103], v[32:35], v[52:55]
  v_add_f32_dpp v64, v49, v48 quad_perm:[1,1,1,1] row_mask:0xf bank_mask:0xf
  v_add_f32_dpp v64, v50, v64 quad_perm:[2,2,2,2] row_mask:0xf bank_mask:0xf
  v_add_f32_dpp v64, v51, v64 quad_perm:[3,3,3,3] row_mask:0xf bank_mask:0xf
  v_add_u32 v130, 1, v130
  ds_write_b32 v131, v130
  s_waitcnt vmcnt(5)
  buffer_load_dwordx4 v[100:103], v9, s[40:43], s35 offen offset:256 nt
  v_mfma_f32_16x16x32_bf16 v[48:51], v[104:107], v[24:27], 0
  s_waitcnt vmcnt(5)
  buffer_load_dwordx4 v[104:107], v10, s[40:43], s35 offen offset:0 nt
  v_mfma_f32_16x16x32_bf16 v[48:51], v[108:111], v[28:31], v[48:51]
  s_waitcnt vmcnt(5)
  buffer_load_dwordx4 v[108:111], v10, s[40:43], s35 offen offset:128 nt
  v_mfma_f32_16x16x32_bf16 v[48:51], v[112:115], v[32:35], v[48:51]
  v_add_f32_dpp v65, v53, v52 quad_perm:[1,1,1,1] row_mask:0xf bank_mask:0xf
  v_add_f32_dpp v65, v54, v65 quad_perm:[2,2,2,2] row_mask:0xf bank_mask:0xf
  v_add_f32_dpp v65, v55, v65 quad_perm:[3,3,3,3] row_mask:0xf bank_mask:0xf
  v_add_u32 v130, 1, v130
  ds_write_b32 v131, v130
  s_waitcnt vmcnt(5)
  buffer_load_dwordx4 v[112:115], v10, s[40:43], s35 offen offset:256 nt
  v_mfma_f32_16x16x32_bf16 v[52:55], v[116:119], v[24:27], 0
  s_waitcnt vmcnt(5)
  buffer_load_dwordx4 v[116:119], v11, s[40:43], s35 offen offset:0 nt
  v_mfma_f32_16x16x32_bf16 v[52:55], v[120:123], v[28:31], v[52:55]
  s_waitcnt vmcnt(5)
  buffer_load_dwordx4 v[120:123], v11, s[40:43], s35 offen offset:128 nt
  v_mfma_f32_16x16x32_bf16 v[52:55], v[124:127], v[32:35], v[52:55]
  v_add_f32_dpp v66, v49, v48 quad_perm:[1,1,1,1] row_mask:0xf bank_mask:0xf
  v_add_f32_dpp v66, v50, v66 quad_perm:[2,2,2,2] row_mask:0xf bank_mask:0xf
  v_add_f32_dpp v66, v51, v66 quad_perm:[3,3,3,3] row_mask:0xf bank_mask:0xf
  s_branch L_ktail
L_kb_3:
  s_waitcnt vmcnt(6)
  buffer_load_dwordx4 v[124:127], v7, s[36:39], s34 offen offset:256 nt
  v_mfma_f32_16x16x32_bf16 v[48:51], v[80:83], v[24:27], 0
  s_waitcnt vmcnt(6)
  buffer_load_dwordx4 v[80:83], v8, s[40:43], s35 offen offset:0 nt
  v_mfma_f32_16x16x32_bf16 v[48:51], v[84:87], v[28:31], v[48:51]
  s_waitcnt vmcnt(6)
  buffer_load_dwordx4 v[84:87], v8, s[40:43], s35 offen offset:128 nt
  v_mfma_f32_16x16x32_bf16 v[48:51], v[88:91], v[32:35], v[48:51]
  v_add_u32 v130, 1, v130
  ds_write_b32 v131, v130
  s_waitcnt vmcnt(6)
  buffer_load_dwordx4 v[88:91], v8, s[40:43], s35 offen offset:256 nt
  v_mfma_f32_16x16x32_bf16 v[52:55], v[92:95], v[24:27], 0
  s_waitcnt vmcnt(6)
  buffer_load_dwordx4 v[92:95], v9, s[40:43], s35 offen offset:0 nt
  v_mfma_f32_16x16x32_bf16 v[52:55], v[96:99], v[28:31], v[52:55]
  s_waitcnt vmcnt(6)
  buffer_load_dwordx4 v[96:99], v9, s[40:43], s35 offen offset:128 nt
  v_mfma_f32_16x16x32_bf16 v[52:55], v[100:103], v[32:35], v[52:55]
  v_add_f32_dpp v64, v49, v48 quad_perm:[1,1,1,1] row_mask:0xf bank_mask:0xf
  v_add_f32_dpp v64, v50, v64 quad_perm:[2,2,2,2] row_mask:0xf bank_mask:0xf
  v_add_f32_dpp v64, v51, v64 quad_perm:[3,3,3,3] row_mask:0xf bank_mask:0xf
  v_add_u32 v130, 1, v130
  ds_write_b32 v131, v130
  s_waitcnt vmcnt(6)
  buffer_load_dwordx4 v[100:103], v9, s[40:43], s35 offen offset:256 nt
  v_mfma_f32_16x16x32_bf16 v[48:51], v[104:107], v[24:27], 0
  s_waitcnt vmcnt(6)
  buffer_load_dwordx4 v[104:107], v10, s[40:43], s35 offen offset:0 nt
  v_mfma_f32_16x16x32_bf16 v[48:51], v[108:111], v[28:31], v[48:51]
  s_waitcnt vmcnt(6)
  buffer_load_dwordx4 v[108:111], v10, s[40:43], s35 offen offset:128 nt
  v_mfma_f32_16x16x32_bf16 v[48:51], v[112:115], v[32:35], v[48:51]
  v_add_f32_dpp v65, v53, v52 quad_perm:[1,1,1,1] row_mask:0xf bank_mask:0xf
  v_add_f32_dpp v65, v54, v65 quad_perm:[2,2,2,2] row_mask:0xf bank_mask:0xf
  v_add_f32_dpp v65, v55, v65 quad_perm:[3,3,3,3] row_mask:0xf bank_mask:0xf
  v_add_u32 v130, 1, v130
  ds_write_b32 v131, v130
  s_waitcnt vmcnt(6)
  buffer_load_dwordx4 v[112:115], v10, s[40:43], s35 offen offset:256 nt
  v_mfma_f32_16x16x32_bf16 v[52:55], v[116:119], v[24:27], 0
  s_waitcnt vmcnt(6)
  buffer_load_dwordx4 v[116:119], v11, s[40:43], s35 offen offset:0 nt
  v_mfma_f32_16x16x32_bf16 v[52:55], v[120:123], v[28:31], v[52:55]
  s_waitcnt vmcnt(6)
  buffer_load_dwordx4 v[120:123], v11, s[40:43], s35 offen offset:128 nt
  v_mfma_f32_16x16x32_bf16 v[52:55], v[124:127], v[32:35], v[52:55]
  v_add_f32_dpp v66, v49, v48 quad_perm:[1,1,1,1] row_mask:0xf bank_mask:0xf
  v_add_f32_dpp v66, v50, v66 quad_perm:[2,2,2,2] row_mask:0xf bank_mask:0xf
  v_add_f32_dpp v66, v51, v66 quad_perm:[3,3,3,3] row_mask:0xf bank_mask:0xf
  s_branch L_ktail
L_kb_4:
  s_waitcnt vmcnt(7)
  buffer_load_dwordx4 v[124:127], v7, s[36:39], s34 offen offset:256 nt
  v_mfma_f32_16x16x32_bf16 v[48:51], v[80:83], v[24:27], 0
  s_waitcnt vmcnt(7)
  buffer_load_dwordx4 v[80:83], v8, s[40:43], s35 offen offset:0 nt
  v_mfma_f32_16x16x32_bf16 v[48:51], v[84:87], v[28:31], v[48:51]
  s_waitcnt vmcnt(7)
  buffer_load_dwordx4 v[84:87], v8, s[40:43], s35 offen offset:128 nt
  v_mfma_f32_16x16x32_bf16 v[48:51], v[88:91], v[32:35], v[48:51]
  v_add_u32 v130, 1, v130
  ds_write_b32 v131, v130
  s_waitcnt vmcnt(7)
  buffer_load_dwordx4 v[88:91], v8, s[40:43], s35 offen offset:256 nt
  v_mfma_f32_16x16x32_bf16 v[52:55], v[92:95], v[24:27], 0
  s_waitcnt vmcnt(7)
  buffer_load_dwordx4 v[92:95], v9, s[40:43], s35 offen offset:0 nt
  v_mfma_f32_16x16x32_bf16 v[52:55], v[96:99], v[28:31], v[52:55]
  s_waitcnt vmcnt(7)
  buffer_load_dwordx4 v[96:99], v9, s[40:43], s35 offen offset:128 nt
  v_mfma_f32_16x16x32_bf16 v[52:55], v[100:103], v[32:35], v[52:55]
  v_add_f32_dpp v64, v49, v48 quad_perm:[1,1,1,1] row_mask:0xf bank_mask:0xf
  v_add_f32_dpp v64, v50, v64 quad_perm:[2,2,2,2] row_mask:0xf bank_mask:0xf
  v_add_f32_dpp v64, v51, v64 quad_perm:[3,3,3,3] row_mask:0xf bank_mask:0xf
  v_add_u32 v130, 1, v130
  ds_write_b32 v131, v130
  s_waitcnt vmcnt(7)
  buffer_load_dwordx4 v[100:103], v9, s[40:43], s35 offen offset:256 nt
  v_mfma_f32_16x16x32_bf16 v[48:51], v[104:107], v[24:27], 0
  s_waitcnt vmcnt(7)
  buffer_load_dwordx4 v[104:107], v10, s[40:43], s35 offen offset:0 nt
  v_mfma_f32_16x16x32_bf16 v[48:51], v[108:111], v[28:31], v[48:51]
  s_waitcnt vmcnt(7)
  buffer_load_dwordx4 v[108:111], v10, s[40:43], s35 offen offset:128 nt
  v_mfma_f32_16x16x32_bf16 v[48:51], v[112:115], v[32:35], v[48:51]
  v_add_f32_dpp v65, v53, v52 quad_perm:[1,1,1,1] row_mask:0xf bank_mask:0xf
  v_add_f32_dpp v65, v54, v65 quad_perm:[2,2,2,2] row_mask:0xf bank_mask:0xf
  v_add_f32_dpp v65, v55, v65 quad_perm:[3,3,3,3] row_mask:0xf bank_mask:0xf
  v_add_u32 v130, 1, v130
  ds_write_b32 v131, v130
  s_waitcnt vmcnt(7)
  buffer_load_dwordx4 v[112:115], v10, s[40:43], s35 offen offset:256 nt
  v_mfma_f32_16x16x32_bf16 v[52:55], v[116:119], v[24:27], 0
  s_waitcnt vmcnt(7)
  buffer_load_dwordx4 v[116:119], v11, s[40:43], s35 offen offset:0 nt
  v_mfma_f32_16x16x32_bf16 v[52:55], v[120:123], v[28:31], v[52:55]
  s_waitcnt vmcnt(7)
  buffer_load_dwordx4 v[120:123], v11, s[40:43], s35 offen offset:128 nt
  v_mfma_f32_16x16x32_bf16 v[52:55], v[124:127], v[32:35], v[52:55]
  v_add_f32_dpp v66, v49, v48 quad_perm:[1,1,1,1] row_mask:0xf bank_mask:0xf
  v_add_f32_dpp v66, v50, v66 quad_perm:[2,2,2,2] row_mask:0xf bank_mask:0xf
  v_add_f32_dpp v66, v51, v66 quad_perm:[3,3,3,3] row_mask:0xf bank_mask:0xf
  s_branch L_ktail
L_kb_5:
  s_waitcnt vmcnt(8)
  buffer_load_dwordx4 v[124:127], v7, s[36:39], s34 offen offset:256 nt
  v_mfma_f32_16x16x32_bf16 v[48:51], v[80:83], v[24:27], 0
  s_waitcnt vmcnt(8)
  buffer_load_dwordx4 v[80:83], v8, s[40:43], s35 offen offset:0 nt
  v_mfma_f32_16x16x32_bf16 v[48:51], v[84:87], v[28:31], v[48:51]
  s_waitcnt vmcnt(8)
  buffer_load_dwordx4 v[84:87], v8, s[40:43], s35 offen offset:128 nt
  v_mfma_f32_16x16x32_bf16 v[48:51], v[88:91], v[32:35], v[48:51]
  v_add_u32 v130, 1, v130
  ds_write_b32 v131, v130
  s_waitcnt vmcnt(8)
  buffer_load_dwordx4 v[88:91], v8, s[40:43], s35 offen offset:256 nt
  v_mfma_f32_16x16x32_bf16 v[52:55], v[92:95], v[24:27], 0
  s_waitcnt vmcnt(8)
  buffer_load_dwordx4 v[92:95], v9, s[40:43], s35 offen offset:0 nt
  v_mfma_f32_16x16x32_bf16 v[52:55], v[96:99], v[28:31], v[52:55]
  s_waitcnt vmcnt(8)
  buffer_load_dwordx4 v[96:99], v9, s[40:43], s35 offen offset:128 nt
  v_mfma_f32_16x16x32_bf16 v[52:55], v[100:103], v[32:35], v[52:55]
  v_add_f32_dpp v64, v49, v48 quad_perm:[1,1,1,1] row_mask:0xf bank_mask:0xf
  v_add_f32_dpp v64, v50, v64 quad_perm:[2,2,2,2] row_mask:0xf bank_mask:0xf
  v_add_f32_dpp v64, v51, v64 quad_perm:[3,3,3,3] row_mask:0xf bank_mask:0xf
  v_add_u32 v130, 1, v130
  ds_write_b32 v131, v130
  s_waitcnt vmcnt(8)
  buffer_load_dwordx4 v[100:103], v9, s[40:43], s35 offen offset:256 nt
  v_mfma_f32_16x16x32_bf16 v[48:51], v[104:107], v[24:27], 0
  s_waitcnt vmcnt(8)
  buffer_load_dwordx4 v[104:107], v10, s[40:43], s35 offen offset:0 nt
  v_mfma_f32_16x16x32_bf16 v[48:51], v[108:111], v[28:31], v[48:51]
  s_waitcnt vmcnt(8)
  buffer_load_dwordx4 v[108:111], v10, s[40:43], s35 offen offset:128 nt
  v_mfma_f32_16x16x32_bf16 v[48:51], v[112:115], v[32:35], v[48:51]
  v_add_f32_dpp v65, v53, v52 quad_perm:[1,1,1,1] row_mask:0xf bank_mask:0xf
  v_add_f32_dpp v65, v54, v65 quad_perm:[2,2,2,2] row_mask:0xf bank_mask:0xf
  v_add_f32_dpp v65, v55, v65 quad_perm:[3,3,3,3] row_mask:0xf bank_mask:0xf
  v_add_u32 v130, 1, v130
  ds_write_b32 v131, v130
  s_waitcnt vmcnt(8)
  buffer_load_dwordx4 v[112:115], v10, s[40:43], s35 offen offset:256 nt
  v_mfma_f32_16x16x32_bf16 v[52:55], v[116:119], v[24:27], 0
  s_waitcnt vmcnt(8)
  buffer_load_dwordx4 v[116:119], v11, s[40:43], s35 offen offset:0 nt
  v_mfma_f32_16x16x32_bf16 v[52:55], v[120:123], v[28:31], v[52:55]
  s_waitcnt vmcnt(8)
  buffer_load_dwordx4 v[120:123], v11, s[40:43], s35 offen offset:128 nt
  v_mfma_f32_16x16x32_bf16 v[52:55], v[124:127], v[32:35], v[52:55]
  v_add_f32_dpp v66, v49, v48 quad_perm:[1,1,1,1] row_mask:0xf bank_mask:0xf
  v_add_f32_dpp v66, v50, v66 quad_perm:[2,2,2,2] row_mask:0xf bank_mask:0xf
  v_add_f32_dpp v66, v51, v66 quad_perm:[3,3,3,3] row_mask:0xf bank_mask:0xf
L_ktail:
  ds_read_b32 v128, v129
  v_add_u32 v130, 1, v130
  ds_write_b32 v131, v130
  s_mov_b32 s34, s35
  s_add_u32 s46, s46, 1
  v_add_f32_dpp v67, v53, v52 quad_perm:[1,1,1,1] row_mask:0xf bank_mask:0xf
  v_add_f32_dpp v67, v54, v67 quad_perm:[2,2,2,2] row_mask:0xf bank_mask:0xf
  v_add_f32_dpp v67, v55, v67 quad_perm:[3,3,3,3] row_mask:0xf bank_mask:0xf
  s_mov_b64 exec, s[62:63]
  ds_write_b128 v16, v[64:67]
  s_mov_b64 exec, -1
  v_add_u32 v16, 128, v16
  s_and_b32 s86, s46, 3
  s_cbranch_scc1 L_kloop
  v_add_u32 v19, v18, v19
  ds_read_b128 v[24:27], v19 offset:0
  ds_read_b128 v[28:31], v19 offset:128
  ds_read_b128 v[32:35], v19 offset:256
  s_cmp_lt_u32 s46, 16
  s_cbranch_scc1 L_kloop
  s_mov_b32 s36, s8
  s_mov_b32 s37, s9
  buffer_load_dwordx4 v[156:159], v14, s[72:75], s71 offen offset:0 nt
  buffer_load_dwordx4 v[160:163], v14, s[72:75], s71 offen offset:128 nt
  buffer_load_dwordx4 v[164:167], v14, s[72:75], s71 offen offset:256 nt
  buffer_load_dwordx4 v[168:171], v15, s[72:75], s71 offen offset:0 nt
  buffer_load_dwordx4 v[172:175], v15, s[72:75], s71 offen offset:128 nt
  buffer_load_dwordx4 v[176:179], v15, s[72:75], s71 offen offset:256 nt
  v_lshl_add_u32 v19, v1, 4, s33
  ds_read_b128 v[68:71], v19
  ds_read_b128 v[72:75], v19 offset:1024
  s_mov_b32 s47, 1033096506
  s_mov_b32 s48, 1069066811
  s_mov_b32 s49, 0xffff0000
  s_lshl_b32 s50, s3, 2
  s_add_u32 s50, s50, 103424
  v_lshrrev_b32 v18, 5, v1
  v_lshl_add_u32 v18, v18, 4, s50
  s_lshl_b32 s50, s3, 9
  s_add_u32 s50, s50, 130304
  v_lshl_add_u32 v16, v1, 2, s50
  s_waitcnt lgkmcnt(0)
  v_cvt_pk_bf16_f32 v64, v68, v69
  v_cvt_pk_bf16_f32 v65, v70, v71
  v_cvt_pk_bf16_f32 v66, v72, v73
  v_cvt_pk_bf16_f32 v67, v74, v75
  v_lshlrev_b32 v68, 16, v64
  v_and_b32 v69, s49, v64
  v_lshlrev_b32 v70, 16, v65
  v_and_b32 v71, s49, v65
  v_lshlrev_b32 v72, 16, v66
  v_and_b32 v73, s49, v66
  v_lshlrev_b32 v74, 16, v67
  v_and_b32 v75, s49, v67
  v_mul_f32 v68, s47, v68
  v_mul_f32 v69, s47, v69
  v_mul_f32 v70, s47, v70
  v_mul_f32 v71, s47, v71
  v_mul_f32 v72, s47, v72
  v_mul_f32 v73, s47, v73
  v_mul_f32 v74, s47, v74
  v_mul_f32 v75, s47, v75
  v_cvt_pk_bf16_f32 v64, v68, v69
  v_cvt_pk_bf16_f32 v65, v70, v71
  v_cvt_pk_bf16_f32 v66, v72, v73
  v_cvt_pk_bf16_f32 v67, v74, v75
  v_lshlrev_b32 v68, 16, v64
  v_and_b32 v69, s49, v64
  v_lshlrev_b32 v70, 16, v65
  v_and_b32 v71, s49, v65
  v_lshlrev_b32 v72, 16, v66
  v_and_b32 v73, s49, v66
  v_lshlrev_b32 v74, 16, v67
  v_and_b32 v75, s49, v67
  v_max3_f32 v76, v68, v69, v70
  v_max3_f32 v77, v72, v73, v74
  v_max_f32 v76, v76, v71
  v_max_f32 v77, v77, v75
  s_nop 0
  s_nop 0
  v_max_f32_dpp v76, v76, v76 quad_perm:[1,0,3,2] row_mask:0xf bank_mask:0xf
  v_max_f32_dpp v77, v77, v77 quad_perm:[1,0,3,2] row_mask:0xf bank_mask:0xf
  s_nop 0
  v_max_f32_dpp v76, v76, v76 quad_perm:[2,3,0,1] row_mask:0xf bank_mask:0xf
  v_max_f32_dpp v77, v77, v77 quad_perm:[2,3,0,1] row_mask:0xf bank_mask:0xf
  s_nop 0
  v_max_f32_dpp v76, v76, v76 row_half_mirror row_mask:0xf bank_mask:0xf
  v_max_f32_dpp v77, v77, v77 row_half_mirror row_mask:0xf bank_mask:0xf
  s_nop 0
  v_max_f32_dpp v76, v76, v76 row_mirror row_mask:0xf bank_mask:0xf
  v_max_f32_dpp v77, v77, v77 row_mirror row_mask:0xf bank_mask:0xf
  v_mov_b32 v78, v76
  v_mov_b32 v79, v77
  s_nop 0
  v_permlane16_swap_b32 v76, v78
  v_permlane16_swap_b32 v77, v79
  v_max_f32 v76, v76, v78
  v_max_f32 v77, v77, v79
  v_sub_f32 v68, v68, v76
  v_sub_f32 v69, v69, v76
  v_sub_f32 v70, v70, v76
  v_sub_f32 v71, v71, v76
  v_sub_f32 v72, v72, v77
  v_sub_f32 v73, v73, v77
  v_sub_f32 v74, v74, v77
  v_sub_f32 v75, v75, v77
  s_mov_b32 exec_lo, 1
  s_mov_b32 exec_hi, 1
  ds_write_b32 v18, v76
  ds_write_b32 v18, v77 offset:32
  s_mov_b64 exec, -1
  v_mul_f32 v68, s48, v68
  v_mul_f32 v69, s48, v69
  v_mul_f32 v70, s48, v70
  v_mul_f32 v71, s48, v71
  v_mul_f32 v72, s48, v72
  v_mul_f32 v73, s48, v73
  v_mul_f32 v74, s48, v74
  v_mul_f32 v75, s48, v75
  v_exp_f32 v68, v68
  v_exp_f32 v69, v69
  v_exp_f32 v70, v70
  v_exp_f32 v71, v71
  v_exp_f32 v72, v72
  v_exp_f32 v73, v73
  v_exp_f32 v74, v74
  v_exp_f32 v75, v75
  v_add_f32 v76, v68, v69
  v_add_f32 v77, v70, v71
  v_add_f32 v78, v72, v73
  v_add_f32 v79, v74, v75
  v_cvt_pk_bf16_f32 v68, v68, v68
  v_cvt_pk_bf16_f32 v69, v69, v69
  v_cvt_pk_bf16_f32 v70, v70, v70
  v_cvt_pk_bf16_f32 v71, v71, v71
  v_cvt_pk_bf16_f32 v72, v72, v72
  v_cvt_pk_bf16_f32 v73, v73, v73
  v_cvt_pk_bf16_f32 v74, v74, v74
  v_cvt_pk_bf16_f32 v75, v75, v75
  ds_write_b128 v19, v[68:71]
  ds_write_b128 v19, v[72:75] offset:1024
  ds_read_b128 v[60:63], v17
  v_add_f32 v76, v76, v77
  v_add_f32 v78, v78, v79
  v_mov_b32 v18, 103488
  v_mov_b32 v19, 1
  ds_write_b32 v16, v76
  ds_write_b32 v16, v78 offset:256
  s_mov_b64 exec, 1
  ds_add_u32 v18, v19 offset:8
  s_mov_b64 exec, -1
  s_mov_b32 s46, 0
  v_lshrrev_b32 v18, 5, v1
  s_lshl_b32 s50, s3, 1
  v_add_u32 v18, s50, v18
  v_mul_u32_u24 v18, 768, v18
  v_lshl_add_u32 v18, v3, 5, v18
  v_and_b32 v68, 16, v1
  v_add_u32 v18, v18, v68
  v_add_u32 v18, 104192, v18
  s_mov_b32 s50, 0x00ff00ff
  s_mov_b32 s51, 0xff00ff00
L_vloop:
  s_add_u32 s86, s46, 1
  s_bfe_u32 s87, s86, 0x20002
  s_mul_i32 s87, s87, 50331648
  s_add_u32 s86, s86, s77
  s_and_b32 s86, s86, 3
  s_mul_i32 s86, s86, 393216
  s_add_u32 s35, s86, s87
  s_waitcnt lgkmcnt(0)
  v_readfirstlane_b32 s84, v128
  s_add_u32 s85, s85, s84
  s_lshr_b32 s84, s85, 4
  s_and_b32 s85, s85, 15
  s_cmp_eq_u32 s84, 1
  s_cbranch_scc1 L_vb_1
  s_cmp_eq_u32 s84, 2
  s_cbranch_scc1 L_vb_2
  s_cmp_eq_u32 s84, 3
  s_cbranch_scc1 L_vb_3
  s_cmp_eq_u32 s84, 4
  s_cbranch_scc1 L_vb_4
  s_cmp_eq_u32 s84, 5
  s_cbranch_scc1 L_vb_5
L_vb_0:
  v_and_b32 v56, v60, v20
  v_and_b32 v57, v60, v21
  v_and_b32 v58, v60, v22
  v_and_b32 v59, v60, v23
  s_nop 0
  s_waitcnt vmcnt(3)
  buffer_load_dwordx4 v[124:127], v15, s[36:39], s34 offen offset:256 nt
  v_mfma_f32_16x16x32_bf16 v[36:39], v[56:59], v[80:83], v[36:39]
  s_waitcnt vmcnt(3)
  buffer_load_dwordx4 v[80:83], v12, s[40:43], s35 offen offset:0 nt
  v_mfma_f32_16x16x32_bf16 v[40:43], v[56:59], v[84:87], v[40:43]
  s_waitcnt vmcnt(3)
  buffer_load_dwordx4 v[84:87], v12, s[40:43], s35 offen offset:128 nt
  v_mfma_f32_16x16x32_bf16 v[44:47], v[56:59], v[88:91], v[44:47]
  v_add_u32 v130, 1, v130
  ds_write_b32 v131, v130
  v_and_b32 v56, v61, v20
  v_and_b32 v57, v61, v21
  v_and_b32 v58, v61, v22
  v_and_b32 v59, v61, v23
  s_nop 0
  s_waitcnt vmcnt(3)
  buffer_load_dwordx4 v[88:91], v12, s[40:43], s35 offen offset:256 nt
  v_mfma_f32_16x16x32_bf16 v[36:39], v[56:59], v[92:95], v[36:39]
  s_waitcnt vmcnt(3)
  buffer_load_dwordx4 v[92:95], v13, s[40:43], s35 offen offset:0 nt
  v_mfma_f32_16x16x32_bf16 v[40:43], v[56:59], v[96:99], v[40:43]
  s_waitcnt vmcnt(3)
  buffer_load_dwordx4 v[96:99], v13, s[40:43], s35 offen offset:128 nt
  v_mfma_f32_16x16x32_bf16 v[44:47], v[56:59], v[100:103], v[44:47]
  v_add_u32 v130, 1, v130
  ds_write_b32 v131, v130
  v_and_b32 v56, v62, v20
  v_and_b32 v57, v62, v21
  v_and_b32 v58, v62, v22
  v_and_b32 v59, v62, v23
  s_nop 0
  s_waitcnt vmcnt(3)
  buffer_load_dwordx4 v[100:103], v13, s[40:43], s35 offen offset:256 nt
  v_mfma_f32_16x16x32_bf16 v[36:39], v[56:59], v[104:107], v[36:39]
  s_waitcnt vmcnt(3)
  buffer_load_dwordx4 v[104:107], v14, s[40:43], s35 offen offset:0 nt
  v_mfma_f32_16x16x32_bf16 v[40:43], v[56:59], v[108:111], v[40:43]
  s_waitcnt vmcnt(3)
  buffer_load_dwordx4 v[108:111], v14, s[40:43], s35 offen offset:128 nt
  v_mfma_f32_16x16x32_bf16 v[44:47], v[56:59], v[112:115], v[44:47]
  v_add_u32 v130, 1, v130
  ds_write_b32 v131, v130
  v_and_b32 v56, v63, v20
  v_and_b32 v57, v63, v21
  v_and_b32 v58, v63, v22
  v_and_b32 v59, v63, v23
  v_add_u32 v17, 128, v17
  ds_read_b128 v[60:63], v17
  s_waitcnt vmcnt(3)
  buffer_load_dwordx4 v[112:115], v14, s[40:43], s35 offen offset:256 nt
  v_mfma_f32_16x16x32_bf16 v[36:39], v[56:59], v[116:119], v[36:39]
  s_waitcnt vmcnt(3)
  buffer_load_dwordx4 v[116:119], v15, s[40:43], s35 offen offset:0 nt
  v_mfma_f32_16x16x32_bf16 v[40:43], v[56:59], v[120:123], v[40:43]
  s_waitcnt vmcnt(3)
  buffer_load_dwordx4 v[120:123], v15, s[40:43], s35 offen offset:128 nt
  v_mfma_f32_16x16x32_bf16 v[44:47], v[56:59], v[124:127], v[44:47]
  s_branch L_vtl
L_vb_1:
  v_and_b32 v56, v60, v20
  v_and_b32 v57, v60, v21
  v_and_b32 v58, v60, v22
  v_and_b32 v59, v60, v23
  s_nop 0
  s_waitcnt vmcnt(4)
  buffer_load_dwordx4 v[124:127], v15, s[36:39], s34 offen offset:256 nt
  v_mfma_f32_16x16x32_bf16 v[36:39], v[56:59], v[80:83], v[36:39]
  s_waitcnt vmcnt(4)
  buffer_load_dwordx4 v[80:83], v12, s[40:43], s35 offen offset:0 nt
  v_mfma_f32_16x16x32_bf16 v[40:43], v[56:59], v[84:87], v[40:43]
  s_waitcnt vmcnt(4)
  buffer_load_dwordx4 v[84:87], v12, s[40:43], s35 offen offset:128 nt
  v_mfma_f32_16x16x32_bf16 v[44:47], v[56:59], v[88:91], v[44:47]
  v_add_u32 v130, 1, v130
  ds_write_b32 v131, v130
  v_and_b32 v56, v61, v20
  v_and_b32 v57, v61, v21
  v_and_b32 v58, v61, v22
  v_and_b32 v59, v61, v23
  s_nop 0
  s_waitcnt vmcnt(4)
  buffer_load_dwordx4 v[88:91], v12, s[40:43], s35 offen offset:256 nt
  v_mfma_f32_16x16x32_bf16 v[36:39], v[56:59], v[92:95], v[36:39]
  s_waitcnt vmcnt(4)
  buffer_load_dwordx4 v[92:95], v13, s[40:43], s35 offen offset:0 nt
  v_mfma_f32_16x16x32_bf16 v[40:43], v[56:59], v[96:99], v[40:43]
  s_waitcnt vmcnt(4)
  buffer_load_dwordx4 v[96:99], v13, s[40:43], s35 offen offset:128 nt
  v_mfma_f32_16x16x32_bf16 v[44:47], v[56:59], v[100:103], v[44:47]
  v_add_u32 v130, 1, v130
  ds_write_b32 v131, v130
  v_and_b32 v56, v62, v20
  v_and_b32 v57, v62, v21
  v_and_b32 v58, v62, v22
  v_and_b32 v59, v62, v23
  s_nop 0
  s_waitcnt vmcnt(4)
  buffer_load_dwordx4 v[100:103], v13, s[40:43], s35 offen offset:256 nt
  v_mfma_f32_16x16x32_bf16 v[36:39], v[56:59], v[104:107], v[36:39]
  s_waitcnt vmcnt(4)
  buffer_load_dwordx4 v[104:107], v14, s[40:43], s35 offen offset:0 nt
  v_mfma_f32_16x16x32_bf16 v[40:43], v[56:59], v[108:111], v[40:43]
  s_waitcnt vmcnt(4)
  buffer_load_dwordx4 v[108:111], v14, s[40:43], s35 offen offset:128 nt
  v_mfma_f32_16x16x32_bf16 v[44:47], v[56:59], v[112:115], v[44:47]
  v_add_u32 v130, 1, v130
  ds_write_b32 v131, v130
  v_and_b32 v56, v63, v20
  v_and_b32 v57, v63, v21
  v_and_b32 v58, v63, v22
  v_and_b32 v59, v63, v23
  v_add_u32 v17, 128, v17
  ds_read_b128 v[60:63], v17
  s_waitcnt vmcnt(4)
  buffer_load_dwordx4 v[112:115], v14, s[40:43], s35 offen offset:256 nt
  v_mfma_f32_16x16x32_bf16 v[36:39], v[56:59], v[116:119], v[36:39]
  s_waitcnt vmcnt(4)
  buffer_load_dwordx4 v[116:119], v15, s[40:43], s35 offen offset:0 nt
  v_mfma_f32_16x16x32_bf16 v[40:43], v[56:59], v[120:123], v[40:43]
  s_waitcnt vmcnt(4)
  buffer_load_dwordx4 v[120:123], v15, s[40:43], s35 offen offset:128 nt
  v_mfma_f32_16x16x32_bf16 v[44:47], v[56:59], v[124:127], v[44:47]
  s_branch L_vtl
L_vb_2:
  v_and_b32 v56, v60, v20
  v_and_b32 v57, v60, v21
  v_and_b32 v58, v60, v22
  v_and_b32 v59, v60, v23
  s_nop 0
  s_waitcnt vmcnt(5)
  buffer_load_dwordx4 v[124:127], v15, s[36:39], s34 offen offset:256 nt
  v_mfma_f32_16x16x32_bf16 v[36:39], v[56:59], v[80:83], v[36:39]
  s_waitcnt vmcnt(5)
  buffer_load_dwordx4 v[80:83], v12, s[40:43], s35 offen offset:0 nt
  v_mfma_f32_16x16x32_bf16 v[40:43], v[56:59], v[84:87], v[40:43]
  s_waitcnt vmcnt(5)
  buffer_load_dwordx4 v[84:87], v12, s[40:43], s35 offen offset:128 nt
  v_mfma_f32_16x16x32_bf16 v[44:47], v[56:59], v[88:91], v[44:47]
  v_add_u32 v130, 1, v130
  ds_write_b32 v131, v130
  v_and_b32 v56, v61, v20
  v_and_b32 v57, v61, v21
  v_and_b32 v58, v61, v22
  v_and_b32 v59, v61, v23
  s_nop 0
  s_waitcnt vmcnt(5)
  buffer_load_dwordx4 v[88:91], v12, s[40:43], s35 offen offset:256 nt
  v_mfma_f32_16x16x32_bf16 v[36:39], v[56:59], v[92:95], v[36:39]
  s_waitcnt vmcnt(5)
  buffer_load_dwordx4 v[92:95], v13, s[40:43], s35 offen offset:0 nt
  v_mfma_f32_16x16x32_bf16 v[40:43], v[56:59], v[96:99], v[40:43]
  s_waitcnt vmcnt(5)
  buffer_load_dwordx4 v[96:99], v13, s[40:43], s35 offen offset:128 nt
  v_mfma_f32_16x16x32_bf16 v[44:47], v[56:59], v[100:103], v[44:47]
  v_add_u32 v130, 1, v130
  ds_write_b32 v131, v130
  v_and_b32 v56, v62, v20
  v_and_b32 v57, v62, v21
  v_and_b32 v58, v62, v22
  v_and_b32 v59, v62, v23
  s_nop 0
  s_waitcnt vmcnt(5)
  buffer_load_dwordx4 v[100:103], v13, s[40:43], s35 offen offset:256 nt
  v_mfma_f32_16x16x32_bf16 v[36:39], v[56:59], v[104:107], v[36:39]
  s_waitcnt vmcnt(5)
  buffer_load_dwordx4 v[104:107], v14, s[40:43], s35 offen offset:0 nt
  v_mfma_f32_16x16x32_bf16 v[40:43], v[56:59], v[108:111], v[40:43]
  s_waitcnt vmcnt(5)
  buffer_load_dwordx4 v[108:111], v14, s[40:43], s35 offen offset:128 nt
  v_mfma_f32_16x16x32_bf16 v[44:47], v[56:59], v[112:115], v[44:47]
  v_add_u32 v130, 1, v130
  ds_write_b32 v131, v130
  v_and_b32 v56, v63, v20
  v_and_b32 v57, v63, v21
  v_and_b32 v58, v63, v22
  v_and_b32 v59, v63, v23
  v_add_u32 v17, 128, v17
  ds_read_b128 v[60:63], v17
  s_waitcnt vmcnt(5)
  buffer_load_dwordx4 v[112:115], v14, s[40:43], s35 offen offset:256 nt
  v_mfma_f32_16x16x32_bf16 v[36:39], v[56:59], v[116:119], v[36:39]
  s_waitcnt vmcnt(5)
  buffer_load_dwordx4 v[116:119], v15, s[40:43], s35 offen offset:0 nt
  v_mfma_f32_16x16x32_bf16 v[40:43], v[56:59], v[120:123], v[40:43]
  s_waitcnt vmcnt(5)
  buffer_load_dwordx4 v[120:123], v15, s[40:43], s35 offen offset:128 nt
  v_mfma_f32_16x16x32_bf16 v[44:47], v[56:59], v[124:127], v[44:47]
  s_branch L_vtl
L_vb_3:
  v_and_b32 v56, v60, v20
  v_and_b32 v57, v60, v21
  v_and_b32 v58, v60, v22
  v_and_b32 v59, v60, v23
  s_nop 0
  s_waitcnt vmcnt(6)
  buffer_load_dwordx4 v[124:127], v15, s[36:39], s34 offen offset:256 nt
  v_mfma_f32_16x16x32_bf16 v[36:39], v[56:59], v[80:83], v[36:39]
  s_waitcnt vmcnt(6)
  buffer_load_dwordx4 v[80:83], v12, s[40:43], s35 offen offset:0 nt
  v_mfma_f32_16x16x32_bf16 v[40:43], v[56:59], v[84:87], v[40:43]
  s_waitcnt vmcnt(6)
  buffer_load_dwordx4 v[84:87], v12, s[40:43], s35 offen offset:128 nt
  v_mfma_f32_16x16x32_bf16 v[44:47], v[56:59], v[88:91], v[44:47]
  v_add_u32 v130, 1, v130
  ds_write_b32 v131, v130
  v_and_b32 v56, v61, v20
  v_and_b32 v57, v61, v21
  v_and_b32 v58, v61, v22
  v_and_b32 v59, v61, v23
  s_nop 0
  s_waitcnt vmcnt(6)
  buffer_load_dwordx4 v[88:91], v12, s[40:43], s35 offen offset:256 nt
  v_mfma_f32_16x16x32_bf16 v[36:39], v[56:59], v[92:95], v[36:39]
  s_waitcnt vmcnt(6)
  buffer_load_dwordx4 v[92:95], v13, s[40:43], s35 offen offset:0 nt
  v_mfma_f32_16x16x32_bf16 v[40:43], v[56:59], v[96:99], v[40:43]
  s_waitcnt vmcnt(6)
  buffer_load_dwordx4 v[96:99], v13, s[40:43], s35 offen offset:128 nt
  v_mfma_f32_16x16x32_bf16 v[44:47], v[56:59], v[100:103], v[44:47]
  v_add_u32 v130, 1, v130
  ds_write_b32 v131, v130
  v_and_b32 v56, v62, v20
  v_and_b32 v57, v62, v21
  v_and_b32 v58, v62, v22
  v_and_b32 v59, v62, v23
  s_nop 0
  s_waitcnt vmcnt(6)
  buffer_load_dwordx4 v[100:103], v13, s[40:43], s35 offen offset:256 nt
  v_mfma_f32_16x16x32_bf16 v[36:39], v[56:59], v[104:107], v[36:39]
  s_waitcnt vmcnt(6)
  buffer_load_dwordx4 v[104:107], v14, s[40:43], s35 offen offset:0 nt
  v_mfma_f32_16x16x32_bf16 v[40:43], v[56:59], v[108:111], v[40:43]
  s_waitcnt vmcnt(6)
  buffer_load_dwordx4 v[108:111], v14, s[40:43], s35 offen offset:128 nt
  v_mfma_f32_16x16x32_bf16 v[44:47], v[56:59], v[112:115], v[44:47]
  v_add_u32 v130, 1, v130
  ds_write_b32 v131, v130
  v_and_b32 v56, v63, v20
  v_and_b32 v57, v63, v21
  v_and_b32 v58, v63, v22
  v_and_b32 v59, v63, v23
  v_add_u32 v17, 128, v17
  ds_read_b128 v[60:63], v17
  s_waitcnt vmcnt(6)
  buffer_load_dwordx4 v[112:115], v14, s[40:43], s35 offen offset:256 nt
  v_mfma_f32_16x16x32_bf16 v[36:39], v[56:59], v[116:119], v[36:39]
  s_waitcnt vmcnt(6)
  buffer_load_dwordx4 v[116:119], v15, s[40:43], s35 offen offset:0 nt
  v_mfma_f32_16x16x32_bf16 v[40:43], v[56:59], v[120:123], v[40:43]
  s_waitcnt vmcnt(6)
  buffer_load_dwordx4 v[120:123], v15, s[40:43], s35 offen offset:128 nt
  v_mfma_f32_16x16x32_bf16 v[44:47], v[56:59], v[124:127], v[44:47]
  s_branch L_vtl
L_vb_4:
  v_and_b32 v56, v60, v20
  v_and_b32 v57, v60, v21
  v_and_b32 v58, v60, v22
  v_and_b32 v59, v60, v23
  s_nop 0
  s_waitcnt vmcnt(7)
  buffer_load_dwordx4 v[124:127], v15, s[36:39], s34 offen offset:256 nt
  v_mfma_f32_16x16x32_bf16 v[36:39], v[56:59], v[80:83], v[36:39]
  s_waitcnt vmcnt(7)
  buffer_load_dwordx4 v[80:83], v12, s[40:43], s35 offen offset:0 nt
  v_mfma_f32_16x16x32_bf16 v[40:43], v[56:59], v[84:87], v[40:43]
  s_waitcnt vmcnt(7)
  buffer_load_dwordx4 v[84:87], v12, s[40:43], s35 offen offset:128 nt
  v_mfma_f32_16x16x32_bf16 v[44:47], v[56:59], v[88:91], v[44:47]
  v_add_u32 v130, 1, v130
  ds_write_b32 v131, v130
  v_and_b32 v56, v61, v20
  v_and_b32 v57, v61, v21
  v_and_b32 v58, v61, v22
  v_and_b32 v59, v61, v23
  s_nop 0
  s_waitcnt vmcnt(7)
  buffer_load_dwordx4 v[88:91], v12, s[40:43], s35 offen offset:256 nt
  v_mfma_f32_16x16x32_bf16 v[36:39], v[56:59], v[92:95], v[36:39]
  s_waitcnt vmcnt(7)
  buffer_load_dwordx4 v[92:95], v13, s[40:43], s35 offen offset:0 nt
  v_mfma_f32_16x16x32_bf16 v[40:43], v[56:59], v[96:99], v[40:43]
  s_waitcnt vmcnt(7)
  buffer_load_dwordx4 v[96:99], v13, s[40:43], s35 offen offset:128 nt
  v_mfma_f32_16x16x32_bf16 v[44:47], v[56:59], v[100:103], v[44:47]
  v_add_u32 v130, 1, v130
  ds_write_b32 v131, v130
  v_and_b32 v56, v62, v20
  v_and_b32 v57, v62, v21
  v_and_b32 v58, v62, v22
  v_and_b32 v59, v62, v23
  s_nop 0
  s_waitcnt vmcnt(7)
  buffer_load_dwordx4 v[100:103], v13, s[40:43], s35 offen offset:256 nt
  v_mfma_f32_16x16x32_bf16 v[36:39], v[56:59], v[104:107], v[36:39]
  s_waitcnt vmcnt(7)
  buffer_load_dwordx4 v[104:107], v14, s[40:43], s35 offen offset:0 nt
  v_mfma_f32_16x16x32_bf16 v[40:43], v[56:59], v[108:111], v[40:43]
  s_waitcnt vmcnt(7)
  buffer_load_dwordx4 v[108:111], v14, s[40:43], s35 offen offset:128 nt
  v_mfma_f32_16x16x32_bf16 v[44:47], v[56:59], v[112:115], v[44:47]
  v_add_u32 v130, 1, v130
  ds_write_b32 v131, v130
  v_and_b32 v56, v63, v20
  v_and_b32 v57, v63, v21
  v_and_b32 v58, v63, v22
  v_and_b32 v59, v63, v23
  v_add_u32 v17, 128, v17
  ds_read_b128 v[60:63], v17
  s_waitcnt vmcnt(7)
  buffer_load_dwordx4 v[112:115], v14, s[40:43], s35 offen offset:256 nt
  v_mfma_f32_16x16x32_bf16 v[36:39], v[56:59], v[116:119], v[36:39]
  s_waitcnt vmcnt(7)
  buffer_load_dwordx4 v[116:119], v15, s[40:43], s35 offen offset:0 nt
  v_mfma_f32_16x16x32_bf16 v[40:43], v[56:59], v[120:123], v[40:43]
  s_waitcnt vmcnt(7)
  buffer_load_dwordx4 v[120:123], v15, s[40:43], s35 offen offset:128 nt
  v_mfma_f32_16x16x32_bf16 v[44:47], v[56:59], v[124:127], v[44:47]
  s_branch L_vtl
L_vb_5:
  v_and_b32 v56, v60, v20
  v_and_b32 v57, v60, v21
  v_and_b32 v58, v60, v22
  v_and_b32 v59, v60, v23
  s_nop 0
  s_waitcnt vmcnt(8)
  buffer_load_dwordx4 v[124:127], v15, s[36:39], s34 offen offset:256 nt
  v_mfma_f32_16x16x32_bf16 v[36:39], v[56:59], v[80:83], v[36:39]
  s_waitcnt vmcnt(8)
  buffer_load_dwordx4 v[80:83], v12, s[40:43], s35 offen offset:0 nt
  v_mfma_f32_16x16x32_bf16 v[40:43], v[56:59], v[84:87], v[40:43]
  s_waitcnt vmcnt(8)
  buffer_load_dwordx4 v[84:87], v12, s[40:43], s35 offen offset:128 nt
  v_mfma_f32_16x16x32_bf16 v[44:47], v[56:59], v[88:91], v[44:47]
  v_add_u32 v130, 1, v130
  ds_write_b32 v131, v130
  v_and_b32 v56, v61, v20
  v_and_b32 v57, v61, v21
  v_and_b32 v58, v61, v22
  v_and_b32 v59, v61, v23
  s_nop 0
  s_waitcnt vmcnt(8)
  buffer_load_dwordx4 v[88:91], v12, s[40:43], s35 offen offset:256 nt
  v_mfma_f32_16x16x32_bf16 v[36:39], v[56:59], v[92:95], v[36:39]
  s_waitcnt vmcnt(8)
  buffer_load_dwordx4 v[92:95], v13, s[40:43], s35 offen offset:0 nt
  v_mfma_f32_16x16x32_bf16 v[40:43], v[56:59], v[96:99], v[40:43]
  s_waitcnt vmcnt(8)
  buffer_load_dwordx4 v[96:99], v13, s[40:43], s35 offen offset:128 nt
  v_mfma_f32_16x16x32_bf16 v[44:47], v[56:59], v[100:103], v[44:47]
  v_add_u32 v130, 1, v130
  ds_write_b32 v131, v130
  v_and_b32 v56, v62, v20
  v_and_b32 v57, v62, v21
  v_and_b32 v58, v62, v22
  v_and_b32 v59, v62, v23
  s_nop 0
  s_waitcnt vmcnt(8)
  buffer_load_dwordx4 v[100:103], v13, s[40:43], s35 offen offset:256 nt
  v_mfma_f32_16x16x32_bf16 v[36:39], v[56:59], v[104:107], v[36:39]
  s_waitcnt vmcnt(8)
  buffer_load_dwordx4 v[104:107], v14, s[40:43], s35 offen offset:0 nt
  v_mfma_f32_16x16x32_bf16 v[40:43], v[56:59], v[108:111], v[40:43]
  s_waitcnt vmcnt(8)
  buffer_load_dwordx4 v[108:111], v14, s[40:43], s35 offen offset:128 nt
  v_mfma_f32_16x16x32_bf16 v[44:47], v[56:59], v[112:115], v[44:47]
  v_add_u32 v130, 1, v130
  ds_write_b32 v131, v130
  v_and_b32 v56, v63, v20
  v_and_b32 v57, v63, v21
  v_and_b32 v58, v63, v22
  v_and_b32 v59, v63, v23
  v_add_u32 v17, 128, v17
  ds_read_b128 v[60:63], v17
  s_waitcnt vmcnt(8)
  buffer_load_dwordx4 v[112:115], v14, s[40:43], s35 offen offset:256 nt
  v_mfma_f32_16x16x32_bf16 v[36:39], v[56:59], v[116:119], v[36:39]
  s_waitcnt vmcnt(8)
  buffer_load_dwordx4 v[116:119], v15, s[40:43], s35 offen offset:0 nt
  v_mfma_f32_16x16x32_bf16 v[40:43], v[56:59], v[120:123], v[40:43]
  s_waitcnt vmcnt(8)
  buffer_load_dwordx4 v[120:123], v15, s[40:43], s35 offen offset:128 nt
  v_mfma_f32_16x16x32_bf16 v[44:47], v[56:59], v[124:127], v[44:47]
L_vtl:
  ds_read_b32 v128, v129
  v_add_u32 v130, 1, v130
  ds_write_b32 v131, v130
  s_mov_b32 s34, s35
  s_add_u32 s46, s46, 1
  s_and_b32 s86, s46, 3
  s_cbranch_scc1 L_vnf
  s_mov_b64 exec, s[50:51]
  ds_write_b128 v18, v[36:39] offset:0
  ds_write_b128 v18, v[40:43] offset:256
  ds_write_b128 v18, v[44:47] offset:512
  s_mov_b64 exec, 1
  ds_add_u32 v129, v19 offset:4
  s_mov_b64 exec, -1
  v_add_u32 v18, 6144, v18
  v_mov_b32 v36, 0
  v_mov_b32 v37, 0
  v_mov_b32 v38, 0
  v_mov_b32 v39, 0
  v_mov_b32 v40, 0
  v_mov_b32 v41, 0
  v_mov_b32 v42, 0
  v_mov_b32 v43, 0
  v_mov_b32 v44, 0
  v_mov_b32 v45, 0
  v_mov_b32 v46, 0
  v_mov_b32 v47, 0
L_vnf:
  s_cmp_lt_u32 s46, 14
  s_cbranch_scc1 L_vloop
  buffer_load_dwordx4 v[124:127], v15, s[36:39], s34 offen offset:256 nt
  ds_read_b128 v[64:67], v17 offset:128
  s_waitcnt lgkmcnt(0)
  v_and_b32 v56, v64, v20
  v_and_b32 v57, v64, v21
  v_and_b32 v58, v64, v22
  v_and_b32 v59, v64, v23
  s_nop 1
  v_mfma_f32_16x16x32_bf16 v[36:39], v[56:59], v[132:135], v[36:39]
  v_mfma_f32_16x16x32_bf16 v[40:43], v[56:59], v[136:139], v[40:43]
  v_mfma_f32_16x16x32_bf16 v[44:47], v[56:59], v[140:143], v[44:47]
  v_and_b32 v56, v65, v20
  v_and_b32 v57, v65, v21
  v_and_b32 v58, v65, v22
  v_and_b32 v59, v65, v23
  s_nop 1
  v_mfma_f32_16x16x32_bf16 v[36:39], v[56:59], v[144:147], v[36:39]
  v_mfma_f32_16x16x32_bf16 v[40:43], v[56:59], v[148:151], v[40:43]
  v_mfma_f32_16x16x32_bf16 v[44:47], v[56:59], v[152:155], v[44:47]
  v_and_b32 v56, v66, v20
  v_and_b32 v57, v66, v21
  v_and_b32 v58, v66, v22
  v_and_b32 v59, v66, v23
  s_nop 1
  v_mfma_f32_16x16x32_bf16 v[36:39], v[56:59], v[156:159], v[36:39]
  v_mfma_f32_16x16x32_bf16 v[40:43], v[56:59], v[160:163], v[40:43]
  v_mfma_f32_16x16x32_bf16 v[44:47], v[56:59], v[164:167], v[44:47]
  v_and_b32 v56, v67, v20
  v_and_b32 v57, v67, v21
  v_and_b32 v58, v67, v22
  v_and_b32 v59, v67, v23
  s_nop 1
  v_mfma_f32_16x16x32_bf16 v[36:39], v[56:59], v[168:171], v[36:39]
  v_mfma_f32_16x16x32_bf16 v[40:43], v[56:59], v[172:175], v[40:43]
  v_mfma_f32_16x16x32_bf16 v[44:47], v[56:59], v[176:179], v[44:47]
  v_and_b32 v56, v60, v20
  v_and_b32 v57, v60, v21
  v_and_b32 v58, v60, v22
  v_and_b32 v59, v60, v23
  s_nop 0
  s_waitcnt vmcnt(11)
  v_mfma_f32_16x16x32_bf16 v[36:39], v[56:59], v[80:83], v[36:39]
  s_waitcnt vmcnt(10)
  v_mfma_f32_16x16x32_bf16 v[40:43], v[56:59], v[84:87], v[40:43]
  s_waitcnt vmcnt(9)
  v_mfma_f32_16x16x32_bf16 v[44:47], v[56:59], v[88:91], v[44:47]
  v_and_b32 v56, v61, v20
  v_and_b32 v57, v61, v21
  v_and_b32 v58, v61, v22
  v_and_b32 v59, v61, v23
  s_nop 0
  s_waitcnt vmcnt(8)
  v_mfma_f32_16x16x32_bf16 v[36:39], v[56:59], v[92:95], v[36:39]
  s_waitcnt vmcnt(7)
  v_mfma_f32_16x16x32_bf16 v[40:43], v[56:59], v[96:99], v[40:43]
  s_waitcnt vmcnt(6)
  v_mfma_f32_16x16x32_bf16 v[44:47], v[56:59], v[100:103], v[44:47]
  v_and_b32 v56, v62, v20
  v_and_b32 v57, v62, v21
  v_and_b32 v58, v62, v22
  v_and_b32 v59, v62, v23
  s_nop 0
  s_waitcnt vmcnt(5)
  v_mfma_f32_16x16x32_bf16 v[36:39], v[56:59], v[104:107], v[36:39]
  s_waitcnt vmcnt(4)
  v_mfma_f32_16x16x32_bf16 v[40:43], v[56:59], v[108:111], v[40:43]
  s_waitcnt vmcnt(3)
  v_mfma_f32_16x16x32_bf16 v[44:47], v[56:59], v[112:115], v[44:47]
  v_and_b32 v56, v63, v20
  v_and_b32 v57, v63, v21
  v_and_b32 v58, v63, v22
  v_and_b32 v59, v63, v23
  s_nop 0
  s_waitcnt vmcnt(2)
  v_mfma_f32_16x16x32_bf16 v[36:39], v[56:59], v[116:119], v[36:39]
  s_waitcnt vmcnt(1)
  v_mfma_f32_16x16x32_bf16 v[40:43], v[56:59], v[120:123], v[40:43]
  s_waitcnt vmcnt(0)
  v_mfma_f32_16x16x32_bf16 v[44:47], v[56:59], v[124:127], v[44:47]
  s_nop 4
  s_mov_b64 exec, s[50:51]
  ds_write_b128 v18, v[36:39] offset:0
  ds_write_b128 v18, v[40:43] offset:256
  ds_write_b128 v18, v[44:47] offset:512
  s_waitcnt lgkmcnt(0)
  s_barrier
  s_endpgm
.section .rodata,"a"
.p2align 6
.amdhsa_kernel recurrent_scan__gqa_block_cached__glu_gated_reglu__decode_kernel
  .amdhsa_next_free_vgpr 184
  .amdhsa_next_free_sgpr 102
  .amdhsa_accum_offset 184
  .amdhsa_group_segment_fixed_size 0
  .amdhsa_kernarg_size 96
  .amdhsa_user_sgpr_count 2
  .amdhsa_user_sgpr_kernarg_segment_ptr 1
  .amdhsa_system_sgpr_workgroup_id_x 1
  .amdhsa_float_denorm_mode_32 3
.end_amdhsa_kernel
```
